```python
import torch

def _softmax(x, axis=-1):
    return torch.softmax(x, dim=axis)
def _gelu(x):
    return torch.nn.functional.gelu(x, approximate="tanh")
def _silu(x):
    return torch.nn.functional.silu(x)
def _sigmoid(x):
    return torch.sigmoid(x)
def _layernorm(x, axis=-1, eps=1e-5):
    m = x.mean(dim=axis, keepdim=True)
    v = x.var(dim=axis, keepdim=True, unbiased=False)
    return (x - m) / torch.sqrt(v + eps)
def _scatter_add(tgt, idx, src, axis=0):
    return tgt.clone().index_add_(axis, idx, src)
def _segment_sum(src, seg, n):
    out = torch.zeros((n,) + src.shape[1:], dtype=src.dtype)
    return out.index_add_(0, seg, src)
def _pad(x, pw):
    flat = tuple(v for pair in reversed(pw) for v in pair)
    return torch.nn.functional.pad(x, flat)

kernel_name = 'interleave_layers__mha_block_cached__dense_activation_gelu__decode'

def setup_inputs():

    _w = (lambda a: (lambda t: t.to(torch.bfloat16) if t.is_floating_point() else t)(torch.as_tensor(a)))
    def _A_setup():
        B, Sq, D = 2, 1, 512
        H, Sk, Dh = 32, 8192, 128
        return {
            "x": _w((lambda *s: torch.randn(*s, dtype=torch.bfloat16) * 0.1)(B, Sq, D)),
            "k_cache": _w((lambda *s: torch.randn(*s, dtype=torch.bfloat16) * 0.8)(B, H, Sk, Dh)),
            "v_cache": _w((lambda *s: torch.randn(*s, dtype=torch.bfloat16) * 3.2)(B, H, Sk, Dh)),
            "wq": _w((lambda *s: torch.randn(*s, dtype=torch.bfloat16) * 0.8)(D, H * Dh) * (D ** -0.5)),
            "wo": _w((lambda *s: torch.randn(*s, dtype=torch.bfloat16) * 3.2)(H * Dh, D) * ((H * Dh) ** -0.5)),
        }
    _A_in = _A_setup()

    def _B_setup():
        B, S, D, F = 2, 1, 512, 1792
        return {
            "x": _w((lambda *s: torch.randn(*s, dtype=torch.bfloat16) * 0.1)(B, S, D)),
            "w1": _w((lambda *s: torch.randn(*s, dtype=torch.bfloat16) * 1.6)(D, F) * (D ** -0.5)),
            "b1": _w((lambda *s: torch.randn(*s, dtype=torch.bfloat16) * 1.6)(F) * 0.01),
            "w2": _w((lambda *s: torch.randn(*s, dtype=torch.bfloat16) * 0.4)(F, D) * (F ** -0.5)),
            "b2": _w((lambda *s: torch.randn(*s, dtype=torch.bfloat16) * 0.4)(D) * 0.01),
        }
    _B_in = _B_setup()

    return {
        "A_x": _A_in["x"],
        "A_k_cache": _A_in["k_cache"],
        "A_v_cache": _A_in["v_cache"],
        "A_wq": _A_in["wq"],
        "A_wo": _A_in["wo"],
        "B_x": _B_in["x"],
        "B_w1": _B_in["w1"],
        "B_b1": _B_in["b1"],
        "B_w2": _B_in["w2"],
        "B_b2": _B_in["b2"],
    }

def reference(A_x, A_k_cache, A_v_cache, A_wq, A_wo, B_x, B_w1, B_b1, B_w2, B_b2):
    def _A_ref(x, k_cache, v_cache, wq, wo):
        B, Sq, D = x.shape
        H, Dh = 32, 128
        q = (lambda x, *d: x.permute(*d))((x @ wq).reshape(B, Sq, H, Dh), 0, 2, 1, 3)
        scores = torch.einsum("bhqd,bhkd->bhqk", q, k_cache) * (Dh ** -0.5)
        p = _softmax(scores, axis=-1)
        o = torch.einsum("bhqk,bhkd->bhqd", p, v_cache)
        return (lambda x, *d: x.permute(*d))(o, 0, 2, 1, 3).reshape(B, Sq, H * Dh) @ wo

    def _B_ref(x, w1, b1, w2, b2):
        h = torch.einsum("bsd,df->bsf", x, w1) + b1
        h = _gelu(h)
        return torch.einsum("bsf,fd->bsd", h, w2) + b2

    x = A_x
    x = x + _A_ref(_layernorm(x, axis=-1), A_k_cache, A_v_cache, A_wq, A_wo)
    x = x + _B_ref(_layernorm(x, axis=-1), B_w1, B_b1, B_w2, B_b2)
    x = x + _A_ref(_layernorm(x, axis=-1), A_k_cache, A_v_cache, A_wq, A_wo)
    x = x + _B_ref(_layernorm(x, axis=-1), B_w1, B_b1, B_w2, B_b2)
    return x
```

```asm
; @launch grid=(256,1,1) block=(256,1,1) lds=163840
.amdgcn_target "amdgcn-amd-amdhsa--gfx950"
.text
.globl interleave_layers__mha_block_cached__dense_activation_gelu__decode_kernel
.p2align 8
.type interleave_layers__mha_block_cached__dense_activation_gelu__decode_kernel,@function
interleave_layers__mha_block_cached__dense_activation_gelu__decode_kernel:
s_cmp_ge_u32 s2, 256
s_cbranch_scc1 L_exit
s_load_dwordx2 s[8:9], s[0:1], 8
s_load_dwordx2 s[12:13], s[0:1], 16
s_and_b32 s82, s2, 7
s_cbranch_scc0 L_chain_entry
s_getpc_b64 s[98:99]
Lpc_1:
v_lshlrev_b32 v2, 7, v0
v_min_u32 v2, L_chain_entry-interleave_layers__mha_block_cached__dense_activation_gelu__decode_kernel-128, v2
s_sub_u32 s98, s98, Lpc_1-interleave_layers__mha_block_cached__dense_activation_gelu__decode_kernel
s_subb_u32 s99, s99, 0
v_mov_b32 v3, s99
v_add_co_u32 v2, vcc, s98, v2
v_addc_co_u32 v3, vcc, 0, v3, vcc
global_load_dword a254, v[2:3], off
global_load_dword a255, v[2:3], off offset:64
L_attn:
v_lshrrev_b32 v1, 6, v0
v_and_b32 v0, 63, v0
v_readfirstlane_b32 s3, v1
v_lshrrev_b32 v1, 4, v0
v_lshlrev_b32 v6, 1, v1
v_and_b32 v38, 15, v0
v_xor_b32 v38, v38, v6
v_lshlrev_b32 v38, 4, v38
v_lshlrev_b32 v1, 8, v1
v_add_u32 v38, v38, v1
v_xor_b32 v39, 0x80, v38
s_lshr_b32 s80, s2, 3
s_lshl_b32 s89, s80, 21
s_lshl2_add_u32 s91, s82, s3
s_lshl_b32 s91, s91, 13
s_add_u32 s91, s91, s89
s_add_u32 s34, s91, 67076096
s_mul_i32 s90, s3, 36864
s_mov_b32 s10, 0x8000000
s_mov_b32 s11, 0x20000
s_mov_b32 s14, 0x8000000
s_mov_b32 s15, 0x20000
s_waitcnt lgkmcnt(0)
s_mov_b32 m0, s90
s_nop 0
buffer_load_dwordx4 v38, s[8:11], s34 offen offset:0 nt lds
buffer_load_dwordx4 v39, s[8:11], s34 offen offset:1024 nt lds
buffer_load_dwordx4 v38, s[8:11], s34 offen offset:2048 nt lds
buffer_load_dwordx4 v39, s[8:11], s34 offen offset:3072 nt lds
s_add_u32 s88, s34, 4096
s_add_u32 m0, s90, 4096
s_nop 0
buffer_load_dwordx4 v38, s[8:11], s88 offen offset:0 nt lds
buffer_load_dwordx4 v39, s[8:11], s88 offen offset:1024 nt lds
buffer_load_dwordx4 v38, s[8:11], s88 offen offset:2048 nt lds
buffer_load_dwordx4 v39, s[8:11], s88 offen offset:3072 nt lds
s_add_u32 m0, s90, 8192
s_nop 0
buffer_load_dwordx4 v38, s[12:15], s34 offen offset:0 nt lds
buffer_load_dwordx4 v39, s[12:15], s34 offen offset:1024 nt lds
buffer_load_dwordx4 v38, s[12:15], s34 offen offset:2048 nt lds
buffer_load_dwordx4 v39, s[12:15], s34 offen offset:3072 nt lds
s_add_u32 s88, s34, 4096
s_add_u32 m0, s90, 12288
s_nop 0
buffer_load_dwordx4 v38, s[12:15], s88 offen offset:0 nt lds
buffer_load_dwordx4 v39, s[12:15], s88 offen offset:1024 nt lds
buffer_load_dwordx4 v38, s[12:15], s88 offen offset:2048 nt lds
buffer_load_dwordx4 v39, s[12:15], s88 offen offset:3072 nt lds
s_load_dwordx2 s[4:5], s[0:1], 96
s_load_dwordx2 s[44:45], s[0:1], 88
s_sub_u32 s82, s82, 1
s_mov_b32 s81, 200000
s_add_u32 s35, s34, 229376
s_add_u32 s36, s35, 229376
s_add_u32 s37, s36, 229376
s_add_u32 s38, s37, 229376
s_add_u32 s39, s38, 229376
s_add_u32 s40, s39, 229376
s_add_u32 s41, s40, 229376
s_add_u32 s42, s41, 229376
s_mov_b32 s6, 0xf0000
s_mov_b32 s7, 0x20000
s_mov_b32 s46, 0x100
s_mov_b32 s47, 0x20000
v_and_b32 v1, 15, v0
v_and_b32 v2, 7, v0
v_lshlrev_b32 v2, 1, v2
v_lshrrev_b32 v4, 4, v0
v_xor_b32 v2, v2, v4
v_lshlrev_b32 v2, 4, v2
v_lshlrev_b32 v1, 8, v1
v_add_u32 v1, v1, v2
v_add_u32 v40, s90, v1
v_xor_b32 v4, 64, v40
v_xor_b32 v5, 128, v40
v_xor_b32 v6, 192, v40
v_lshrrev_b32 v1, 2, v0
v_and_b32 v2, 7, v1
v_lshlrev_b32 v2, 1, v2
v_lshlrev_b32 v1, 8, v1
v_bfe_u32 v8, v0, 1, 1
v_xor_b32 v2, v2, v8
v_lshlrev_b32 v2, 4, v2
v_add_u32 v1, v1, v2
v_and_b32 v2, 1, v0
v_lshlrev_b32 v2, 3, v2
v_add_u32 v1, v1, v2
v_add_u32 v41, s90, v1
v_xor_b32 v8, 32, v41
v_xor_b32 v9, 64, v41
v_xor_b32 v10, 96, v41
v_xor_b32 v11, 128, v41
v_xor_b32 v12, 160, v41
v_xor_b32 v13, 192, v41
v_xor_b32 v14, 224, v41
s_mov_b32 s16, 0x10001
s_mov_b32 s17, 0x10001
s_mov_b32 s18, 0x20002
s_mov_b32 s19, 0x20002
s_mov_b32 s20, 0x40004
s_mov_b32 s21, 0x40004
s_mov_b32 s22, 0x80008
s_mov_b32 s23, 0x80008
s_mov_b32 s24, 0x100010
s_mov_b32 s25, 0x100010
s_mov_b32 s26, 0x200020
s_mov_b32 s27, 0x200020
s_mov_b32 s28, 0x400040
s_mov_b32 s29, 0x400040
s_mov_b32 s30, 0x800080
s_mov_b32 s31, 0x800080
v_lshlrev_b32 v1, 2, v0
v_add_u32 v1, 148480, v1
v_mov_b32 v2, 0
s_mov_b32 exec_lo, 0xffff
s_mov_b32 exec_hi, 0x0
ds_write_b32 v1, v2
s_mov_b64 exec, -1
s_waitcnt lgkmcnt(0)
s_barrier
v_mov_b32 v36, 0xff800000
v_mov_b32 v37, 0
v_mov_b32 v32, 0
v_mov_b32 v33, 0
v_mov_b32 v34, 0
v_mov_b32 v35, 0
s_mov_b32 s95, 1600000
s_mov_b32 s83, 0
s_waitcnt vmcnt(12)
s_add_u32 m0, s90, 20480
s_nop 0
buffer_load_dwordx4 v38, s[8:11], s42 offen offset:0 nt lds
buffer_load_dwordx4 v39, s[8:11], s42 offen offset:1024 nt lds
buffer_load_dwordx4 v38, s[8:11], s42 offen offset:2048 nt lds
buffer_load_dwordx4 v39, s[8:11], s42 offen offset:3072 nt lds
ds_read_b128 v[48:51], v40 offset:0
v_xor_b32 v46, 64, v40
ds_read_b128 v[52:55], v46 offset:0
v_xor_b32 v47, 128, v40
ds_read_b128 v[56:59], v47 offset:0
v_xor_b32 v46, 192, v40
ds_read_b128 v[60:63], v46 offset:0
s_waitcnt lgkmcnt(0)
s_waitcnt vmcnt(12)
s_add_u32 s88, s42, 4096
s_add_u32 m0, s90, 24576
s_nop 0
buffer_load_dwordx4 v38, s[8:11], s88 offen offset:0 nt lds
buffer_load_dwordx4 v39, s[8:11], s88 offen offset:1024 nt lds
buffer_load_dwordx4 v38, s[8:11], s88 offen offset:2048 nt lds
buffer_load_dwordx4 v39, s[8:11], s88 offen offset:3072 nt lds
ds_read_b128 v[64:67], v40 offset:4096
v_xor_b32 v46, 64, v40
ds_read_b128 v[68:71], v46 offset:4096
v_xor_b32 v47, 128, v40
ds_read_b128 v[72:75], v47 offset:4096
v_xor_b32 v46, 192, v40
ds_read_b128 v[76:79], v46 offset:4096
s_waitcnt lgkmcnt(0)
s_waitcnt vmcnt(12)
s_add_u32 m0, s90, 16384
s_nop 0
buffer_load_dwordx4 v38, s[8:11], s35 offen offset:0 nt lds
buffer_load_dwordx4 v39, s[8:11], s35 offen offset:1024 nt lds
buffer_load_dwordx4 v38, s[8:11], s35 offen offset:2048 nt lds
buffer_load_dwordx4 v39, s[8:11], s35 offen offset:3072 nt lds
ds_read_b64_tr_b16 a[0:1], v41 offset:8192
v_xor_b32 v46, 32, v41
ds_read_b64_tr_b16 a[8:9], v46 offset:8192
v_xor_b32 v47, 64, v41
ds_read_b64_tr_b16 a[16:17], v47 offset:8192
v_xor_b32 v46, 96, v41
ds_read_b64_tr_b16 a[24:25], v46 offset:8192
v_xor_b32 v47, 128, v41
ds_read_b64_tr_b16 a[32:33], v47 offset:8192
v_xor_b32 v46, 160, v41
ds_read_b64_tr_b16 a[40:41], v46 offset:8192
v_xor_b32 v47, 192, v41
ds_read_b64_tr_b16 a[48:49], v47 offset:8192
v_xor_b32 v46, 224, v41
ds_read_b64_tr_b16 a[56:57], v46 offset:8192
s_waitcnt lgkmcnt(0)
s_waitcnt vmcnt(12)
s_add_u32 s88, s35, 4096
s_mov_b32 m0, s90
s_nop 0
buffer_load_dwordx4 v38, s[8:11], s88 offen offset:0 nt lds
buffer_load_dwordx4 v39, s[8:11], s88 offen offset:1024 nt lds
buffer_load_dwordx4 v38, s[8:11], s88 offen offset:2048 nt lds
buffer_load_dwordx4 v39, s[8:11], s88 offen offset:3072 nt lds
ds_read_b64_tr_b16 a[2:3], v41 offset:12288
v_xor_b32 v46, 32, v41
ds_read_b64_tr_b16 a[10:11], v46 offset:12288
v_xor_b32 v47, 64, v41
ds_read_b64_tr_b16 a[18:19], v47 offset:12288
v_xor_b32 v46, 96, v41
ds_read_b64_tr_b16 a[26:27], v46 offset:12288
v_xor_b32 v47, 128, v41
ds_read_b64_tr_b16 a[34:35], v47 offset:12288
v_xor_b32 v46, 160, v41
ds_read_b64_tr_b16 a[42:43], v46 offset:12288
v_xor_b32 v47, 192, v41
ds_read_b64_tr_b16 a[50:51], v47 offset:12288
v_xor_b32 v46, 224, v41
ds_read_b64_tr_b16 a[58:59], v46 offset:12288
s_waitcnt lgkmcnt(0)
s_cmp_lg_u32 s3, 0
s_cbranch_scc1 Lw0_2
buffer_load_dword v20, off, s[44:47], 0 sc1
Lw0_2:
s_waitcnt vmcnt(12)
s_add_u32 m0, s90, 4096
s_nop 0
buffer_load_dwordx4 v38, s[12:15], s35 offen offset:0 nt lds
buffer_load_dwordx4 v39, s[12:15], s35 offen offset:1024 nt lds
buffer_load_dwordx4 v38, s[12:15], s35 offen offset:2048 nt lds
buffer_load_dwordx4 v39, s[12:15], s35 offen offset:3072 nt lds
s_waitcnt vmcnt(12)
s_add_u32 s88, s35, 4096
s_add_u32 m0, s90, 8192
s_nop 0
buffer_load_dwordx4 v38, s[12:15], s88 offen offset:0 nt lds
buffer_load_dwordx4 v39, s[12:15], s88 offen offset:1024 nt lds
buffer_load_dwordx4 v38, s[12:15], s88 offen offset:2048 nt lds
buffer_load_dwordx4 v39, s[12:15], s88 offen offset:3072 nt lds
s_waitcnt vmcnt(12)
s_add_u32 m0, s90, 28672
s_nop 0
buffer_load_dwordx4 v38, s[12:15], s42 offen offset:0 nt lds
buffer_load_dwordx4 v39, s[12:15], s42 offen offset:1024 nt lds
buffer_load_dwordx4 v38, s[12:15], s42 offen offset:2048 nt lds
buffer_load_dwordx4 v39, s[12:15], s42 offen offset:3072 nt lds
ds_read_b128 v[80:83], v40 offset:16384
v_xor_b32 v46, 64, v40
ds_read_b128 v[84:87], v46 offset:16384
v_xor_b32 v47, 128, v40
ds_read_b128 v[88:91], v47 offset:16384
v_xor_b32 v46, 192, v40
ds_read_b128 v[92:95], v46 offset:16384
s_waitcnt lgkmcnt(0)
s_waitcnt vmcnt(12)
s_add_u32 s88, s42, 4096
s_add_u32 m0, s90, 32768
s_nop 0
buffer_load_dwordx4 v38, s[12:15], s88 offen offset:0 nt lds
buffer_load_dwordx4 v39, s[12:15], s88 offen offset:1024 nt lds
buffer_load_dwordx4 v38, s[12:15], s88 offen offset:2048 nt lds
buffer_load_dwordx4 v39, s[12:15], s88 offen offset:3072 nt lds
ds_read_b128 v[96:99], v40 offset:0
v_xor_b32 v46, 64, v40
ds_read_b128 v[100:103], v46 offset:0
v_xor_b32 v47, 128, v40
ds_read_b128 v[104:107], v47 offset:0
v_xor_b32 v46, 192, v40
ds_read_b128 v[108:111], v46 offset:0
s_waitcnt lgkmcnt(0)
s_waitcnt vmcnt(12)
s_add_u32 m0, s90, 12288
s_nop 0
buffer_load_dwordx4 v38, s[8:11], s36 offen offset:0 nt lds
buffer_load_dwordx4 v39, s[8:11], s36 offen offset:1024 nt lds
buffer_load_dwordx4 v38, s[8:11], s36 offen offset:2048 nt lds
buffer_load_dwordx4 v39, s[8:11], s36 offen offset:3072 nt lds
ds_read_b64_tr_b16 a[4:5], v41 offset:4096
v_xor_b32 v46, 32, v41
ds_read_b64_tr_b16 a[12:13], v46 offset:4096
v_xor_b32 v47, 64, v41
ds_read_b64_tr_b16 a[20:21], v47 offset:4096
v_xor_b32 v46, 96, v41
ds_read_b64_tr_b16 a[28:29], v46 offset:4096
v_xor_b32 v47, 128, v41
ds_read_b64_tr_b16 a[36:37], v47 offset:4096
v_xor_b32 v46, 160, v41
ds_read_b64_tr_b16 a[44:45], v46 offset:4096
v_xor_b32 v47, 192, v41
ds_read_b64_tr_b16 a[52:53], v47 offset:4096
v_xor_b32 v46, 224, v41
ds_read_b64_tr_b16 a[60:61], v46 offset:4096
s_waitcnt lgkmcnt(0)
s_waitcnt vmcnt(12)
s_add_u32 s88, s36, 4096
s_add_u32 m0, s90, 16384
s_nop 0
buffer_load_dwordx4 v38, s[8:11], s88 offen offset:0 nt lds
buffer_load_dwordx4 v39, s[8:11], s88 offen offset:1024 nt lds
buffer_load_dwordx4 v38, s[8:11], s88 offen offset:2048 nt lds
buffer_load_dwordx4 v39, s[8:11], s88 offen offset:3072 nt lds
ds_read_b64_tr_b16 a[6:7], v41 offset:8192
v_xor_b32 v46, 32, v41
ds_read_b64_tr_b16 a[14:15], v46 offset:8192
v_xor_b32 v47, 64, v41
ds_read_b64_tr_b16 a[22:23], v47 offset:8192
v_xor_b32 v46, 96, v41
ds_read_b64_tr_b16 a[30:31], v46 offset:8192
v_xor_b32 v47, 128, v41
ds_read_b64_tr_b16 a[38:39], v47 offset:8192
v_xor_b32 v46, 160, v41
ds_read_b64_tr_b16 a[46:47], v46 offset:8192
v_xor_b32 v47, 192, v41
ds_read_b64_tr_b16 a[54:55], v47 offset:8192
v_xor_b32 v46, 224, v41
ds_read_b64_tr_b16 a[62:63], v46 offset:8192
s_waitcnt lgkmcnt(0)
s_cmp_lg_u32 s3, 0
s_cbranch_scc1 Lw0_3
s_waitcnt vmcnt(24)
v_and_b32 v20, 63, v20
v_cmp_ne_u32 vcc, 32, v20
s_nop 1
s_cbranch_vccz Larrok_4
v_mov_b32 v21, 0
s_nop 1
Larr_5:
buffer_load_dword v20, v21, s[44:47], 0 offen sc1
s_waitcnt vmcnt(0)
v_and_b32 v22, 63, v20
v_cmp_ne_u32 vcc, 32, v22
s_nop 1
s_cbranch_vccz Larrd_6
s_sub_u32 s81, s81, 1
s_cbranch_scc0 Larr_5
s_mov_b32 s81, 0
Larrd_6:
Larrok_4:
v_mbcnt_lo_u32_b32 v46, -1, 0
v_mbcnt_hi_u32_b32 v46, -1, v46
v_lshrrev_b32 v47, 4, v46
v_and_b32 v46, 15, v46
v_lshlrev_b32 v46, 4, v46
s_mov_b32 s88, 196608
v_mul_lo_u32 v47, v47, s88
v_add_u32 v46, v46, v47
s_lshl_b32 s94, s80, 8
s_mov_b32 exec_lo, 0xffffffff
s_mov_b32 exec_hi, 0x0
buffer_load_dwordx4 v[16:19], v46, s[4:7], s94 offen offset:0 sc1
s_mov_b64 exec, -1
Lw0_3:
s_waitcnt vmcnt(12)
s_mov_b32 m0, s90
s_nop 0
buffer_load_dwordx4 v38, s[12:15], s36 offen offset:0 nt lds
buffer_load_dwordx4 v39, s[12:15], s36 offen offset:1024 nt lds
buffer_load_dwordx4 v38, s[12:15], s36 offen offset:2048 nt lds
buffer_load_dwordx4 v39, s[12:15], s36 offen offset:3072 nt lds
s_waitcnt vmcnt(12)
s_add_u32 s88, s36, 4096
s_add_u32 m0, s90, 4096
s_nop 0
buffer_load_dwordx4 v38, s[12:15], s88 offen offset:0 nt lds
buffer_load_dwordx4 v39, s[12:15], s88 offen offset:1024 nt lds
buffer_load_dwordx4 v38, s[12:15], s88 offen offset:2048 nt lds
buffer_load_dwordx4 v39, s[12:15], s88 offen offset:3072 nt lds
s_waitcnt vmcnt(12)
s_add_u32 m0, s90, 8192
s_nop 0
buffer_load_dwordx4 v38, s[8:11], s37 offen offset:0 nt lds
buffer_load_dwordx4 v39, s[8:11], s37 offen offset:1024 nt lds
buffer_load_dwordx4 v38, s[8:11], s37 offen offset:2048 nt lds
buffer_load_dwordx4 v39, s[8:11], s37 offen offset:3072 nt lds
ds_read_b128 v[112:115], v40 offset:12288
v_xor_b32 v46, 64, v40
ds_read_b128 v[116:119], v46 offset:12288
v_xor_b32 v47, 128, v40
ds_read_b128 v[120:123], v47 offset:12288
v_xor_b32 v46, 192, v40
ds_read_b128 v[124:127], v46 offset:12288
s_waitcnt lgkmcnt(0)
s_waitcnt vmcnt(12)
s_add_u32 s88, s37, 4096
s_add_u32 m0, s90, 12288
s_nop 0
buffer_load_dwordx4 v38, s[8:11], s88 offen offset:0 nt lds
buffer_load_dwordx4 v39, s[8:11], s88 offen offset:1024 nt lds
buffer_load_dwordx4 v38, s[8:11], s88 offen offset:2048 nt lds
buffer_load_dwordx4 v39, s[8:11], s88 offen offset:3072 nt lds
ds_read_b128 v[128:131], v40 offset:16384
v_xor_b32 v46, 64, v40
ds_read_b128 v[132:135], v46 offset:16384
v_xor_b32 v47, 128, v40
ds_read_b128 v[136:139], v47 offset:16384
v_xor_b32 v46, 192, v40
ds_read_b128 v[140:143], v46 offset:16384
s_waitcnt lgkmcnt(0)
s_waitcnt vmcnt(12)
s_add_u32 m0, s90, 16384
s_nop 0
buffer_load_dwordx4 v38, s[12:15], s37 offen offset:0 nt lds
buffer_load_dwordx4 v39, s[12:15], s37 offen offset:1024 nt lds
buffer_load_dwordx4 v38, s[12:15], s37 offen offset:2048 nt lds
buffer_load_dwordx4 v39, s[12:15], s37 offen offset:3072 nt lds
ds_read_b64_tr_b16 a[64:65], v41 offset:0
v_xor_b32 v46, 32, v41
ds_read_b64_tr_b16 a[72:73], v46 offset:0
v_xor_b32 v47, 64, v41
ds_read_b64_tr_b16 a[80:81], v47 offset:0
v_xor_b32 v46, 96, v41
ds_read_b64_tr_b16 a[88:89], v46 offset:0
v_xor_b32 v47, 128, v41
ds_read_b64_tr_b16 a[96:97], v47 offset:0
v_xor_b32 v46, 160, v41
ds_read_b64_tr_b16 a[104:105], v46 offset:0
v_xor_b32 v47, 192, v41
ds_read_b64_tr_b16 a[112:113], v47 offset:0
v_xor_b32 v46, 224, v41
ds_read_b64_tr_b16 a[120:121], v46 offset:0
s_waitcnt lgkmcnt(0)
s_waitcnt vmcnt(12)
s_add_u32 s88, s37, 4096
s_mov_b32 m0, s90
s_nop 0
buffer_load_dwordx4 v38, s[12:15], s88 offen offset:0 nt lds
buffer_load_dwordx4 v39, s[12:15], s88 offen offset:1024 nt lds
buffer_load_dwordx4 v38, s[12:15], s88 offen offset:2048 nt lds
buffer_load_dwordx4 v39, s[12:15], s88 offen offset:3072 nt lds
ds_read_b64_tr_b16 a[66:67], v41 offset:4096
v_xor_b32 v46, 32, v41
ds_read_b64_tr_b16 a[74:75], v46 offset:4096
v_xor_b32 v47, 64, v41
ds_read_b64_tr_b16 a[82:83], v47 offset:4096
v_xor_b32 v46, 96, v41
ds_read_b64_tr_b16 a[90:91], v46 offset:4096
v_xor_b32 v47, 128, v41
ds_read_b64_tr_b16 a[98:99], v47 offset:4096
v_xor_b32 v46, 160, v41
ds_read_b64_tr_b16 a[106:107], v46 offset:4096
v_xor_b32 v47, 192, v41
ds_read_b64_tr_b16 a[114:115], v47 offset:4096
v_xor_b32 v46, 224, v41
ds_read_b64_tr_b16 a[122:123], v46 offset:4096
s_waitcnt lgkmcnt(0)
s_cmp_lg_u32 s3, 0
s_cbranch_scc1 Lw0_7
s_waitcnt vmcnt(24)
s_mov_b32 exec_lo, 0xffffffff
s_mov_b32 exec_hi, 0x0
v_max3_u32 v42, v16, v17, v18
v_max_u32 v42, v42, v19
v_cmp_eq_u32 vcc, -1, v42
s_nop 1
s_cbranch_vccz Lqok_8
s_mov_b64 exec, -1
v_mbcnt_lo_u32_b32 v46, -1, 0
v_mbcnt_hi_u32_b32 v46, -1, v46
v_lshrrev_b32 v47, 4, v46
v_and_b32 v46, 15, v46
v_lshlrev_b32 v46, 4, v46
s_mov_b32 s88, 196608
v_mul_lo_u32 v47, v47, s88
v_add_u32 v46, v46, v47
s_lshl_b32 s94, s80, 8
s_mov_b32 exec_lo, 0xffffffff
s_mov_b32 exec_hi, 0x0
Lpoll_9:
buffer_load_dwordx4 v[16:19], v46, s[4:7], s94 offen offset:0 sc1
s_waitcnt vmcnt(0)
v_max3_u32 v42, v16, v17, v18
v_max_u32 v42, v42, v19
v_cmp_eq_u32 vcc, -1, v42
s_nop 1
s_cbranch_vccz Lpdone_10
s_sub_u32 s81, s81, 1
s_cbranch_scc0 Lpoll_9
s_mov_b32 s81, 0
Lpdone_10:
Lqok_8:
v_mbcnt_lo_u32_b32 v46, -1, 0
v_mbcnt_hi_u32_b32 v46, -1, v46
v_lshlrev_b32 v46, 4, v46
v_add_u32 v46, 147456, v46
ds_write_b128 v46, v[16:19]
s_mov_b64 exec, -1
v_mov_b32 v46, 148500
v_mov_b32 v47, 1
ds_write_b32 v46, v47
s_nop 0
Lw0_7:
v_mov_b32 v46, 148500
s_nop 1
Lfw_11:
ds_read_b32 v47, v46
s_waitcnt lgkmcnt(0)
v_cmp_eq_u32 vcc, 0, v47
s_nop 1
s_cbranch_vccz Lfwd_12
s_sub_u32 s95, s95, 1
s_cbranch_scc0 Lfw_11
s_mov_b32 s95, 0
Lfwd_12:
v_mbcnt_lo_u32_b32 v46, -1, 0
v_mbcnt_hi_u32_b32 v46, -1, v46
v_lshrrev_b32 v46, 4, v46
v_lshlrev_b32 v46, 4, v46
v_add_u32 v46, 147712, v46
ds_read_b128 v[0:3], v46 offset:0
ds_read_b128 v[4:7], v46 offset:64
ds_read_b128 v[8:11], v46 offset:128
ds_read_b128 v[12:15], v46 offset:192
s_waitcnt lgkmcnt(0)
s_mov_b32 s85, 1
L_it:
s_cmp_eq_u32 s83, 0
s_cbranch_scc1 Lsk_13
s_waitcnt vmcnt(12)
ds_read_b128 v[48:51], v40 offset:0
v_xor_b32 v46, 64, v40
ds_read_b128 v[52:55], v46 offset:0
v_xor_b32 v47, 128, v40
ds_read_b128 v[56:59], v47 offset:0
v_xor_b32 v46, 192, v40
ds_read_b128 v[60:63], v46 offset:0
s_waitcnt lgkmcnt(0)
s_add_u32 m0, s90, 16384
s_nop 0
buffer_load_dwordx4 v38, s[8:11], s35 offen offset:0 nt lds
buffer_load_dwordx4 v39, s[8:11], s35 offen offset:1024 nt lds
buffer_load_dwordx4 v38, s[8:11], s35 offen offset:2048 nt lds
buffer_load_dwordx4 v39, s[8:11], s35 offen offset:3072 nt lds
s_waitcnt vmcnt(12)
ds_read_b128 v[64:67], v40 offset:4096
v_xor_b32 v46, 64, v40
ds_read_b128 v[68:71], v46 offset:4096
v_xor_b32 v47, 128, v40
ds_read_b128 v[72:75], v47 offset:4096
v_xor_b32 v46, 192, v40
ds_read_b128 v[76:79], v46 offset:4096
s_waitcnt lgkmcnt(0)
s_add_u32 s88, s35, 4096
s_mov_b32 m0, s90
s_nop 0
buffer_load_dwordx4 v38, s[8:11], s88 offen offset:0 nt lds
buffer_load_dwordx4 v39, s[8:11], s88 offen offset:1024 nt lds
buffer_load_dwordx4 v38, s[8:11], s88 offen offset:2048 nt lds
buffer_load_dwordx4 v39, s[8:11], s88 offen offset:3072 nt lds
Lsk_13:
v_mfma_f32_16x16x32_bf16 v[16:19], v[48:51], v[0:3], 0
v_mfma_f32_16x16x32_bf16 v[20:23], v[64:67], v[0:3], 0
v_mfma_f32_16x16x32_bf16 v[16:19], v[52:55], v[4:7], v[16:19]
v_mfma_f32_16x16x32_bf16 v[20:23], v[68:71], v[4:7], v[20:23]
v_mfma_f32_16x16x32_bf16 v[16:19], v[56:59], v[8:11], v[16:19]
v_mfma_f32_16x16x32_bf16 v[20:23], v[72:75], v[8:11], v[20:23]
v_mfma_f32_16x16x32_bf16 v[16:19], v[60:63], v[12:15], v[16:19]
v_mfma_f32_16x16x32_bf16 v[20:23], v[76:79], v[12:15], v[20:23]
s_nop 6
v_max3_f32 v42, v16, v17, v18
v_max3_f32 v43, v20, v21, v22
v_max3_f32 v42, v42, v19, v23
v_max3_f32 v42, v42, v43, v36
v_mov_b32 v43, v42
s_nop 1
v_permlane16_swap_b32 v42, v43
v_max_f32 v42, v42, v43
v_mov_b32 v43, v42
s_nop 1
v_permlane32_swap_b32 v42, v43
v_max_f32 v42, v42, v43
v_sub_f32 v43, v36, v42
v_exp_f32 v43, v43
v_mov_b32 v36, v42
v_sub_f32 v16, v16, v42
v_sub_f32 v17, v17, v42
v_sub_f32 v18, v18, v42
v_sub_f32 v19, v19, v42
v_sub_f32 v20, v20, v42
v_sub_f32 v21, v21, v42
v_sub_f32 v22, v22, v42
v_sub_f32 v23, v23, v42
v_exp_f32 v16, v16
v_exp_f32 v17, v17
v_exp_f32 v18, v18
v_exp_f32 v19, v19
v_exp_f32 v20, v20
v_exp_f32 v21, v21
v_exp_f32 v22, v22
v_exp_f32 v23, v23
v_mul_f32 v37, v37, v43
v_mul_f32 v32, v32, v43
v_mul_f32 v33, v33, v43
v_mul_f32 v34, v34, v43
v_mul_f32 v35, v35, v43
v_add_f32 v44, v16, v17
v_add_f32 v45, v18, v19
v_add_f32 v44, v44, v20
v_add_f32 v45, v45, v21
v_add_f32 v44, v44, v22
v_add_f32 v45, v45, v23
v_add_f32 v37, v37, v44
v_add_f32 v37, v37, v45
v_cvt_pk_bf16_f32 v16, v16, v17
v_cvt_pk_bf16_f32 v17, v18, v19
v_cvt_pk_bf16_f32 v18, v20, v21
v_cvt_pk_bf16_f32 v19, v22, v23
s_cmp_eq_u32 s83, 0
s_nop 0
s_cbranch_scc1 Lsk_14
s_waitcnt vmcnt(12)
ds_read_b64_tr_b16 a[0:1], v41 offset:8192
v_xor_b32 v46, 32, v41
ds_read_b64_tr_b16 a[8:9], v46 offset:8192
v_xor_b32 v47, 64, v41
ds_read_b64_tr_b16 a[16:17], v47 offset:8192
v_xor_b32 v46, 96, v41
ds_read_b64_tr_b16 a[24:25], v46 offset:8192
v_xor_b32 v47, 128, v41
ds_read_b64_tr_b16 a[32:33], v47 offset:8192
v_xor_b32 v46, 160, v41
ds_read_b64_tr_b16 a[40:41], v46 offset:8192
v_xor_b32 v47, 192, v41
ds_read_b64_tr_b16 a[48:49], v47 offset:8192
v_xor_b32 v46, 224, v41
ds_read_b64_tr_b16 a[56:57], v46 offset:8192
s_waitcnt lgkmcnt(0)
s_add_u32 m0, s90, 4096
s_nop 0
buffer_load_dwordx4 v38, s[12:15], s35 offen offset:0 nt lds
buffer_load_dwordx4 v39, s[12:15], s35 offen offset:1024 nt lds
buffer_load_dwordx4 v38, s[12:15], s35 offen offset:2048 nt lds
buffer_load_dwordx4 v39, s[12:15], s35 offen offset:3072 nt lds
s_waitcnt vmcnt(12)
ds_read_b64_tr_b16 a[2:3], v41 offset:12288
v_xor_b32 v46, 32, v41
ds_read_b64_tr_b16 a[10:11], v46 offset:12288
v_xor_b32 v47, 64, v41
ds_read_b64_tr_b16 a[18:19], v47 offset:12288
v_xor_b32 v46, 96, v41
ds_read_b64_tr_b16 a[26:27], v46 offset:12288
v_xor_b32 v47, 128, v41
ds_read_b64_tr_b16 a[34:35], v47 offset:12288
v_xor_b32 v46, 160, v41
ds_read_b64_tr_b16 a[42:43], v46 offset:12288
v_xor_b32 v47, 192, v41
ds_read_b64_tr_b16 a[50:51], v47 offset:12288
v_xor_b32 v46, 224, v41
ds_read_b64_tr_b16 a[58:59], v46 offset:12288
s_waitcnt lgkmcnt(0)
s_add_u32 s88, s35, 4096
s_add_u32 m0, s90, 8192
s_nop 0
buffer_load_dwordx4 v38, s[12:15], s88 offen offset:0 nt lds
buffer_load_dwordx4 v39, s[12:15], s88 offen offset:1024 nt lds
buffer_load_dwordx4 v38, s[12:15], s88 offen offset:2048 nt lds
buffer_load_dwordx4 v39, s[12:15], s88 offen offset:3072 nt lds
Lsk_14:
v_cndmask_b32_e64 v24, 0, v16, s[16:17]
v_cndmask_b32_e64 v25, 0, v17, s[16:17]
v_cndmask_b32_e64 v26, 0, v18, s[16:17]
v_cndmask_b32_e64 v27, 0, v19, s[16:17]
v_cndmask_b32_e64 v28, 0, v16, s[18:19]
v_cndmask_b32_e64 v29, 0, v17, s[18:19]
v_cndmask_b32_e64 v30, 0, v18, s[18:19]
v_cndmask_b32_e64 v31, 0, v19, s[18:19]
v_mfma_f32_16x16x32_bf16 v[32:35], a[0:3], v[24:27], v[32:35]
v_cndmask_b32_e64 v24, 0, v16, s[20:21]
v_cndmask_b32_e64 v25, 0, v17, s[20:21]
v_cndmask_b32_e64 v26, 0, v18, s[20:21]
v_cndmask_b32_e64 v27, 0, v19, s[20:21]
v_mfma_f32_16x16x32_bf16 v[32:35], a[8:11], v[28:31], v[32:35]
v_cndmask_b32_e64 v28, 0, v16, s[22:23]
v_cndmask_b32_e64 v29, 0, v17, s[22:23]
v_cndmask_b32_e64 v30, 0, v18, s[22:23]
v_cndmask_b32_e64 v31, 0, v19, s[22:23]
v_mfma_f32_16x16x32_bf16 v[32:35], a[16:19], v[24:27], v[32:35]
v_cndmask_b32_e64 v24, 0, v16, s[24:25]
v_cndmask_b32_e64 v25, 0, v17, s[24:25]
v_cndmask_b32_e64 v26, 0, v18, s[24:25]
v_cndmask_b32_e64 v27, 0, v19, s[24:25]
v_mfma_f32_16x16x32_bf16 v[32:35], a[24:27], v[28:31], v[32:35]
v_cndmask_b32_e64 v28, 0, v16, s[26:27]
v_cndmask_b32_e64 v29, 0, v17, s[26:27]
v_cndmask_b32_e64 v30, 0, v18, s[26:27]
v_cndmask_b32_e64 v31, 0, v19, s[26:27]
v_mfma_f32_16x16x32_bf16 v[32:35], a[32:35], v[24:27], v[32:35]
v_cndmask_b32_e64 v24, 0, v16, s[28:29]
v_cndmask_b32_e64 v25, 0, v17, s[28:29]
v_cndmask_b32_e64 v26, 0, v18, s[28:29]
v_cndmask_b32_e64 v27, 0, v19, s[28:29]
v_mfma_f32_16x16x32_bf16 v[32:35], a[40:43], v[28:31], v[32:35]
v_cndmask_b32_e64 v28, 0, v16, s[30:31]
v_cndmask_b32_e64 v29, 0, v17, s[30:31]
v_cndmask_b32_e64 v30, 0, v18, s[30:31]
v_cndmask_b32_e64 v31, 0, v19, s[30:31]
v_mfma_f32_16x16x32_bf16 v[32:35], a[48:51], v[24:27], v[32:35]
s_nop 0
v_mfma_f32_16x16x32_bf16 v[32:35], a[56:59], v[28:31], v[32:35]
s_cmp_eq_u32 s83, 0
s_nop 6
s_cbranch_scc1 Lsk_15
s_waitcnt vmcnt(12)
ds_read_b128 v[80:83], v40 offset:16384
v_xor_b32 v46, 64, v40
ds_read_b128 v[84:87], v46 offset:16384
v_xor_b32 v47, 128, v40
ds_read_b128 v[88:91], v47 offset:16384
v_xor_b32 v46, 192, v40
ds_read_b128 v[92:95], v46 offset:16384
s_waitcnt lgkmcnt(0)
s_add_u32 m0, s90, 12288
s_nop 0
buffer_load_dwordx4 v38, s[8:11], s36 offen offset:0 nt lds
buffer_load_dwordx4 v39, s[8:11], s36 offen offset:1024 nt lds
buffer_load_dwordx4 v38, s[8:11], s36 offen offset:2048 nt lds
buffer_load_dwordx4 v39, s[8:11], s36 offen offset:3072 nt lds
s_waitcnt vmcnt(12)
ds_read_b128 v[96:99], v40 offset:0
v_xor_b32 v46, 64, v40
ds_read_b128 v[100:103], v46 offset:0
v_xor_b32 v47, 128, v40
ds_read_b128 v[104:107], v47 offset:0
v_xor_b32 v46, 192, v40
ds_read_b128 v[108:111], v46 offset:0
s_waitcnt lgkmcnt(0)
s_add_u32 s88, s36, 4096
s_add_u32 m0, s90, 16384
s_nop 0
buffer_load_dwordx4 v38, s[8:11], s88 offen offset:0 nt lds
buffer_load_dwordx4 v39, s[8:11], s88 offen offset:1024 nt lds
buffer_load_dwordx4 v38, s[8:11], s88 offen offset:2048 nt lds
buffer_load_dwordx4 v39, s[8:11], s88 offen offset:3072 nt lds
Lsk_15:
v_mfma_f32_16x16x32_bf16 v[16:19], v[80:83], v[0:3], 0
v_mfma_f32_16x16x32_bf16 v[20:23], v[96:99], v[0:3], 0
v_mfma_f32_16x16x32_bf16 v[16:19], v[84:87], v[4:7], v[16:19]
v_mfma_f32_16x16x32_bf16 v[20:23], v[100:103], v[4:7], v[20:23]
v_mfma_f32_16x16x32_bf16 v[16:19], v[88:91], v[8:11], v[16:19]
v_mfma_f32_16x16x32_bf16 v[20:23], v[104:107], v[8:11], v[20:23]
v_mfma_f32_16x16x32_bf16 v[16:19], v[92:95], v[12:15], v[16:19]
v_mfma_f32_16x16x32_bf16 v[20:23], v[108:111], v[12:15], v[20:23]
s_nop 6
v_max3_f32 v42, v16, v17, v18
v_max3_f32 v43, v20, v21, v22
v_max3_f32 v42, v42, v19, v23
v_max3_f32 v42, v42, v43, v36
v_mov_b32 v43, v42
s_nop 1
v_permlane16_swap_b32 v42, v43
v_max_f32 v42, v42, v43
v_mov_b32 v43, v42
s_nop 1
v_permlane32_swap_b32 v42, v43
v_max_f32 v42, v42, v43
v_sub_f32 v43, v36, v42
v_exp_f32 v43, v43
v_mov_b32 v36, v42
v_sub_f32 v16, v16, v42
v_sub_f32 v17, v17, v42
v_sub_f32 v18, v18, v42
v_sub_f32 v19, v19, v42
v_sub_f32 v20, v20, v42
v_sub_f32 v21, v21, v42
v_sub_f32 v22, v22, v42
v_sub_f32 v23, v23, v42
v_exp_f32 v16, v16
v_exp_f32 v17, v17
v_exp_f32 v18, v18
v_exp_f32 v19, v19
v_exp_f32 v20, v20
v_exp_f32 v21, v21
v_exp_f32 v22, v22
v_exp_f32 v23, v23
v_mul_f32 v37, v37, v43
v_mul_f32 v32, v32, v43
v_mul_f32 v33, v33, v43
v_mul_f32 v34, v34, v43
v_mul_f32 v35, v35, v43
v_add_f32 v44, v16, v17
v_add_f32 v45, v18, v19
v_add_f32 v44, v44, v20
v_add_f32 v45, v45, v21
v_add_f32 v44, v44, v22
v_add_f32 v45, v45, v23
v_add_f32 v37, v37, v44
v_add_f32 v37, v37, v45
v_cvt_pk_bf16_f32 v16, v16, v17
v_cvt_pk_bf16_f32 v17, v18, v19
v_cvt_pk_bf16_f32 v18, v20, v21
v_cvt_pk_bf16_f32 v19, v22, v23
s_cmp_eq_u32 s83, 0
s_nop 0
s_cbranch_scc1 Lsk_16
s_waitcnt vmcnt(12)
ds_read_b64_tr_b16 a[4:5], v41 offset:4096
v_xor_b32 v46, 32, v41
ds_read_b64_tr_b16 a[12:13], v46 offset:4096
v_xor_b32 v47, 64, v41
ds_read_b64_tr_b16 a[20:21], v47 offset:4096
v_xor_b32 v46, 96, v41
ds_read_b64_tr_b16 a[28:29], v46 offset:4096
v_xor_b32 v47, 128, v41
ds_read_b64_tr_b16 a[36:37], v47 offset:4096
v_xor_b32 v46, 160, v41
ds_read_b64_tr_b16 a[44:45], v46 offset:4096
v_xor_b32 v47, 192, v41
ds_read_b64_tr_b16 a[52:53], v47 offset:4096
v_xor_b32 v46, 224, v41
ds_read_b64_tr_b16 a[60:61], v46 offset:4096
s_waitcnt lgkmcnt(0)
s_add_u32 m0, s90, 20480
s_nop 0
buffer_load_dwordx4 v38, s[8:11], s42 offen offset:0 nt lds
buffer_load_dwordx4 v39, s[8:11], s42 offen offset:1024 nt lds
buffer_load_dwordx4 v38, s[8:11], s42 offen offset:2048 nt lds
buffer_load_dwordx4 v39, s[8:11], s42 offen offset:3072 nt lds
s_waitcnt vmcnt(12)
ds_read_b64_tr_b16 a[6:7], v41 offset:8192
v_xor_b32 v46, 32, v41
ds_read_b64_tr_b16 a[14:15], v46 offset:8192
v_xor_b32 v47, 64, v41
ds_read_b64_tr_b16 a[22:23], v47 offset:8192
v_xor_b32 v46, 96, v41
ds_read_b64_tr_b16 a[30:31], v46 offset:8192
v_xor_b32 v47, 128, v41
ds_read_b64_tr_b16 a[38:39], v47 offset:8192
v_xor_b32 v46, 160, v41
ds_read_b64_tr_b16 a[46:47], v46 offset:8192
v_xor_b32 v47, 192, v41
ds_read_b64_tr_b16 a[54:55], v47 offset:8192
v_xor_b32 v46, 224, v41
ds_read_b64_tr_b16 a[62:63], v46 offset:8192
s_waitcnt lgkmcnt(0)
s_add_u32 s88, s42, 4096
s_add_u32 m0, s90, 24576
s_nop 0
buffer_load_dwordx4 v38, s[8:11], s88 offen offset:0 nt lds
buffer_load_dwordx4 v39, s[8:11], s88 offen offset:1024 nt lds
buffer_load_dwordx4 v38, s[8:11], s88 offen offset:2048 nt lds
buffer_load_dwordx4 v39, s[8:11], s88 offen offset:3072 nt lds
Lsk_16:
v_cndmask_b32_e64 v24, 0, v16, s[16:17]
v_cndmask_b32_e64 v25, 0, v17, s[16:17]
v_cndmask_b32_e64 v26, 0, v18, s[16:17]
v_cndmask_b32_e64 v27, 0, v19, s[16:17]
v_cndmask_b32_e64 v28, 0, v16, s[18:19]
v_cndmask_b32_e64 v29, 0, v17, s[18:19]
v_cndmask_b32_e64 v30, 0, v18, s[18:19]
v_cndmask_b32_e64 v31, 0, v19, s[18:19]
v_mfma_f32_16x16x32_bf16 v[32:35], a[4:7], v[24:27], v[32:35]
v_cndmask_b32_e64 v24, 0, v16, s[20:21]
v_cndmask_b32_e64 v25, 0, v17, s[20:21]
v_cndmask_b32_e64 v26, 0, v18, s[20:21]
v_cndmask_b32_e64 v27, 0, v19, s[20:21]
v_mfma_f32_16x16x32_bf16 v[32:35], a[12:15], v[28:31], v[32:35]
v_cndmask_b32_e64 v28, 0, v16, s[22:23]
v_cndmask_b32_e64 v29, 0, v17, s[22:23]
v_cndmask_b32_e64 v30, 0, v18, s[22:23]
v_cndmask_b32_e64 v31, 0, v19, s[22:23]
v_mfma_f32_16x16x32_bf16 v[32:35], a[20:23], v[24:27], v[32:35]
v_cndmask_b32_e64 v24, 0, v16, s[24:25]
v_cndmask_b32_e64 v25, 0, v17, s[24:25]
v_cndmask_b32_e64 v26, 0, v18, s[24:25]
v_cndmask_b32_e64 v27, 0, v19, s[24:25]
v_mfma_f32_16x16x32_bf16 v[32:35], a[28:31], v[28:31], v[32:35]
v_cndmask_b32_e64 v28, 0, v16, s[26:27]
v_cndmask_b32_e64 v29, 0, v17, s[26:27]
v_cndmask_b32_e64 v30, 0, v18, s[26:27]
v_cndmask_b32_e64 v31, 0, v19, s[26:27]
v_mfma_f32_16x16x32_bf16 v[32:35], a[36:39], v[24:27], v[32:35]
v_cndmask_b32_e64 v24, 0, v16, s[28:29]
v_cndmask_b32_e64 v25, 0, v17, s[28:29]
v_cndmask_b32_e64 v26, 0, v18, s[28:29]
v_cndmask_b32_e64 v27, 0, v19, s[28:29]
v_mfma_f32_16x16x32_bf16 v[32:35], a[44:47], v[28:31], v[32:35]
v_cndmask_b32_e64 v28, 0, v16, s[30:31]
v_cndmask_b32_e64 v29, 0, v17, s[30:31]
v_cndmask_b32_e64 v30, 0, v18, s[30:31]
v_cndmask_b32_e64 v31, 0, v19, s[30:31]
v_mfma_f32_16x16x32_bf16 v[32:35], a[52:55], v[24:27], v[32:35]
s_nop 0
v_mfma_f32_16x16x32_bf16 v[32:35], a[60:63], v[28:31], v[32:35]
s_cmp_eq_u32 s83, 0
s_nop 6
s_cbranch_scc1 Lsk_17
s_waitcnt vmcnt(12)
ds_read_b128 v[112:115], v40 offset:12288
v_xor_b32 v46, 64, v40
ds_read_b128 v[116:119], v46 offset:12288
v_xor_b32 v47, 128, v40
ds_read_b128 v[120:123], v47 offset:12288
v_xor_b32 v46, 192, v40
ds_read_b128 v[124:127], v46 offset:12288
s_waitcnt lgkmcnt(0)
s_add_u32 m0, s90, 28672
s_nop 0
buffer_load_dwordx4 v38, s[12:15], s42 offen offset:0 nt lds
buffer_load_dwordx4 v39, s[12:15], s42 offen offset:1024 nt lds
buffer_load_dwordx4 v38, s[12:15], s42 offen offset:2048 nt lds
buffer_load_dwordx4 v39, s[12:15], s42 offen offset:3072 nt lds
s_waitcnt vmcnt(12)
ds_read_b128 v[128:131], v40 offset:16384
v_xor_b32 v46, 64, v40
ds_read_b128 v[132:135], v46 offset:16384
v_xor_b32 v47, 128, v40
ds_read_b128 v[136:139], v47 offset:16384
v_xor_b32 v46, 192, v40
ds_read_b128 v[140:143], v46 offset:16384
s_waitcnt lgkmcnt(0)
s_add_u32 s88, s42, 4096
s_add_u32 m0, s90, 32768
s_nop 0
buffer_load_dwordx4 v38, s[12:15], s88 offen offset:0 nt lds
buffer_load_dwordx4 v39, s[12:15], s88 offen offset:1024 nt lds
buffer_load_dwordx4 v38, s[12:15], s88 offen offset:2048 nt lds
buffer_load_dwordx4 v39, s[12:15], s88 offen offset:3072 nt lds
Lsk_17:
s_cmp_eq_u32 s83, 0
s_cbranch_scc1 Ldq_18
s_waitcnt vmcnt(8)
Ldq_18:
ds_read_b128 a[196:199], v40 offset:20480
ds_read_b128 a[228:231], v40 offset:24576
v_xor_b32 v46, 64, v40
ds_read_b128 a[204:207], v46 offset:20480
ds_read_b128 a[236:239], v46 offset:24576
v_xor_b32 v47, 128, v40
ds_read_b128 a[212:215], v47 offset:20480
ds_read_b128 a[244:247], v47 offset:24576
v_xor_b32 v46, 192, v40
ds_read_b128 a[220:223], v46 offset:20480
ds_read_b128 a[252:255], v46 offset:24576
s_waitcnt lgkmcnt(0)
s_cmp_eq_u32 s83, 0
s_cbranch_scc1 Lsk_19
s_mov_b32 m0, s90
s_nop 0
buffer_load_dwordx4 v38, s[12:15], s36 offen offset:0 nt lds
buffer_load_dwordx4 v39, s[12:15], s36 offen offset:1024 nt lds
buffer_load_dwordx4 v38, s[12:15], s36 offen offset:2048 nt lds
buffer_load_dwordx4 v39, s[12:15], s36 offen offset:3072 nt lds
s_add_u32 s88, s36, 4096
s_add_u32 m0, s90, 4096
s_nop 0
buffer_load_dwordx4 v38, s[12:15], s88 offen offset:0 nt lds
buffer_load_dwordx4 v39, s[12:15], s88 offen offset:1024 nt lds
buffer_load_dwordx4 v38, s[12:15], s88 offen offset:2048 nt lds
buffer_load_dwordx4 v39, s[12:15], s88 offen offset:3072 nt lds
Lsk_19:
v_mfma_f32_16x16x32_bf16 v[16:19], a[196:199], v[0:3], 0
v_mfma_f32_16x16x32_bf16 v[20:23], a[228:231], v[0:3], 0
v_mfma_f32_16x16x32_bf16 v[16:19], a[204:207], v[4:7], v[16:19]
v_mfma_f32_16x16x32_bf16 v[20:23], a[236:239], v[4:7], v[20:23]
v_mfma_f32_16x16x32_bf16 v[16:19], a[212:215], v[8:11], v[16:19]
v_mfma_f32_16x16x32_bf16 v[20:23], a[244:247], v[8:11], v[20:23]
v_mfma_f32_16x16x32_bf16 v[16:19], a[220:223], v[12:15], v[16:19]
v_mfma_f32_16x16x32_bf16 v[20:23], a[252:255], v[12:15], v[20:23]
s_cmp_eq_u32 s83, 0
s_nop 6
s_cbranch_scc1 Ldq_20
s_waitcnt vmcnt(8)
Ldq_20:
ds_read_b64_tr_b16 a[196:197], v41 offset:28672
ds_read_b64_tr_b16 a[198:199], v41 offset:32768
v_xor_b32 v46, 32, v41
ds_read_b64_tr_b16 a[204:205], v46 offset:28672
ds_read_b64_tr_b16 a[206:207], v46 offset:32768
v_xor_b32 v47, 64, v41
ds_read_b64_tr_b16 a[212:213], v47 offset:28672
ds_read_b64_tr_b16 a[214:215], v47 offset:32768
v_xor_b32 v46, 96, v41
ds_read_b64_tr_b16 a[220:221], v46 offset:28672
ds_read_b64_tr_b16 a[222:223], v46 offset:32768
v_xor_b32 v47, 128, v41
ds_read_b64_tr_b16 a[228:229], v47 offset:28672
ds_read_b64_tr_b16 a[230:231], v47 offset:32768
v_xor_b32 v46, 160, v41
ds_read_b64_tr_b16 a[236:237], v46 offset:28672
ds_read_b64_tr_b16 a[238:239], v46 offset:32768
v_xor_b32 v47, 192, v41
ds_read_b64_tr_b16 a[244:245], v47 offset:28672
ds_read_b64_tr_b16 a[246:247], v47 offset:32768
v_xor_b32 v46, 224, v41
ds_read_b64_tr_b16 a[252:253], v46 offset:28672
ds_read_b64_tr_b16 a[254:255], v46 offset:32768
v_max3_f32 v42, v16, v17, v18
v_max3_f32 v43, v20, v21, v22
v_max3_f32 v42, v42, v19, v23
v_max3_f32 v42, v42, v43, v36
v_mov_b32 v43, v42
s_nop 1
v_permlane16_swap_b32 v42, v43
v_max_f32 v42, v42, v43
v_mov_b32 v43, v42
s_nop 1
v_permlane32_swap_b32 v42, v43
v_max_f32 v42, v42, v43
v_sub_f32 v43, v36, v42
v_exp_f32 v43, v43
v_mov_b32 v36, v42
v_sub_f32 v16, v16, v42
v_sub_f32 v17, v17, v42
v_sub_f32 v18, v18, v42
v_sub_f32 v19, v19, v42
v_sub_f32 v20, v20, v42
v_sub_f32 v21, v21, v42
v_sub_f32 v22, v22, v42
v_sub_f32 v23, v23, v42
v_exp_f32 v16, v16
v_exp_f32 v17, v17
v_exp_f32 v18, v18
v_exp_f32 v19, v19
v_exp_f32 v20, v20
v_exp_f32 v21, v21
v_exp_f32 v22, v22
v_exp_f32 v23, v23
v_mul_f32 v37, v37, v43
v_mul_f32 v32, v32, v43
v_mul_f32 v33, v33, v43
v_mul_f32 v34, v34, v43
v_mul_f32 v35, v35, v43
v_add_f32 v44, v16, v17
v_add_f32 v45, v18, v19
v_add_f32 v44, v44, v20
v_add_f32 v45, v45, v21
v_add_f32 v44, v44, v22
v_add_f32 v45, v45, v23
v_add_f32 v37, v37, v44
v_add_f32 v37, v37, v45
v_cvt_pk_bf16_f32 v16, v16, v17
v_cvt_pk_bf16_f32 v17, v18, v19
v_cvt_pk_bf16_f32 v18, v20, v21
v_cvt_pk_bf16_f32 v19, v22, v23
s_waitcnt lgkmcnt(0)
s_cmp_eq_u32 s83, 0
s_cbranch_scc1 Lsk_21
s_add_u32 m0, s90, 8192
s_nop 0
buffer_load_dwordx4 v38, s[8:11], s37 offen offset:0 nt lds
buffer_load_dwordx4 v39, s[8:11], s37 offen offset:1024 nt lds
buffer_load_dwordx4 v38, s[8:11], s37 offen offset:2048 nt lds
buffer_load_dwordx4 v39, s[8:11], s37 offen offset:3072 nt lds
s_add_u32 s88, s37, 4096
s_add_u32 m0, s90, 12288
s_nop 0
buffer_load_dwordx4 v38, s[8:11], s88 offen offset:0 nt lds
buffer_load_dwordx4 v39, s[8:11], s88 offen offset:1024 nt lds
buffer_load_dwordx4 v38, s[8:11], s88 offen offset:2048 nt lds
buffer_load_dwordx4 v39, s[8:11], s88 offen offset:3072 nt lds
Lsk_21:
v_cndmask_b32_e64 v24, 0, v16, s[16:17]
v_cndmask_b32_e64 v25, 0, v17, s[16:17]
v_cndmask_b32_e64 v26, 0, v18, s[16:17]
v_cndmask_b32_e64 v27, 0, v19, s[16:17]
v_cndmask_b32_e64 v28, 0, v16, s[18:19]
v_cndmask_b32_e64 v29, 0, v17, s[18:19]
v_cndmask_b32_e64 v30, 0, v18, s[18:19]
v_cndmask_b32_e64 v31, 0, v19, s[18:19]
v_mfma_f32_16x16x32_bf16 v[32:35], a[196:199], v[24:27], v[32:35]
v_cndmask_b32_e64 v24, 0, v16, s[20:21]
v_cndmask_b32_e64 v25, 0, v17, s[20:21]
v_cndmask_b32_e64 v26, 0, v18, s[20:21]
v_cndmask_b32_e64 v27, 0, v19, s[20:21]
v_mfma_f32_16x16x32_bf16 v[32:35], a[204:207], v[28:31], v[32:35]
v_cndmask_b32_e64 v28, 0, v16, s[22:23]
v_cndmask_b32_e64 v29, 0, v17, s[22:23]
v_cndmask_b32_e64 v30, 0, v18, s[22:23]
v_cndmask_b32_e64 v31, 0, v19, s[22:23]
v_mfma_f32_16x16x32_bf16 v[32:35], a[212:215], v[24:27], v[32:35]
v_cndmask_b32_e64 v24, 0, v16, s[24:25]
v_cndmask_b32_e64 v25, 0, v17, s[24:25]
v_cndmask_b32_e64 v26, 0, v18, s[24:25]
v_cndmask_b32_e64 v27, 0, v19, s[24:25]
v_mfma_f32_16x16x32_bf16 v[32:35], a[220:223], v[28:31], v[32:35]
v_cndmask_b32_e64 v28, 0, v16, s[26:27]
v_cndmask_b32_e64 v29, 0, v17, s[26:27]
v_cndmask_b32_e64 v30, 0, v18, s[26:27]
v_cndmask_b32_e64 v31, 0, v19, s[26:27]
v_mfma_f32_16x16x32_bf16 v[32:35], a[228:231], v[24:27], v[32:35]
v_cndmask_b32_e64 v24, 0, v16, s[28:29]
v_cndmask_b32_e64 v25, 0, v17, s[28:29]
v_cndmask_b32_e64 v26, 0, v18, s[28:29]
v_cndmask_b32_e64 v27, 0, v19, s[28:29]
v_mfma_f32_16x16x32_bf16 v[32:35], a[236:239], v[28:31], v[32:35]
v_cndmask_b32_e64 v28, 0, v16, s[30:31]
v_cndmask_b32_e64 v29, 0, v17, s[30:31]
v_cndmask_b32_e64 v30, 0, v18, s[30:31]
v_cndmask_b32_e64 v31, 0, v19, s[30:31]
v_mfma_f32_16x16x32_bf16 v[32:35], a[244:247], v[24:27], v[32:35]
s_nop 0
v_mfma_f32_16x16x32_bf16 v[32:35], a[252:255], v[28:31], v[32:35]
v_mfma_f32_16x16x32_bf16 v[16:19], v[112:115], v[0:3], 0
v_mfma_f32_16x16x32_bf16 v[20:23], v[128:131], v[0:3], 0
v_mfma_f32_16x16x32_bf16 v[16:19], v[116:119], v[4:7], v[16:19]
v_mfma_f32_16x16x32_bf16 v[20:23], v[132:135], v[4:7], v[20:23]
v_mfma_f32_16x16x32_bf16 v[16:19], v[120:123], v[8:11], v[16:19]
v_mfma_f32_16x16x32_bf16 v[20:23], v[136:139], v[8:11], v[20:23]
v_mfma_f32_16x16x32_bf16 v[16:19], v[124:127], v[12:15], v[16:19]
v_mfma_f32_16x16x32_bf16 v[20:23], v[140:143], v[12:15], v[20:23]
s_nop 6
v_max3_f32 v42, v16, v17, v18
v_max3_f32 v43, v20, v21, v22
v_max3_f32 v42, v42, v19, v23
v_max3_f32 v42, v42, v43, v36
v_mov_b32 v43, v42
s_nop 1
v_permlane16_swap_b32 v42, v43
v_max_f32 v42, v42, v43
v_mov_b32 v43, v42
s_nop 1
v_permlane32_swap_b32 v42, v43
v_max_f32 v42, v42, v43
v_sub_f32 v43, v36, v42
v_exp_f32 v43, v43
v_mov_b32 v36, v42
v_sub_f32 v16, v16, v42
v_sub_f32 v17, v17, v42
v_sub_f32 v18, v18, v42
v_sub_f32 v19, v19, v42
v_sub_f32 v20, v20, v42
v_sub_f32 v21, v21, v42
v_sub_f32 v22, v22, v42
v_sub_f32 v23, v23, v42
v_exp_f32 v16, v16
v_exp_f32 v17, v17
v_exp_f32 v18, v18
v_exp_f32 v19, v19
v_exp_f32 v20, v20
v_exp_f32 v21, v21
v_exp_f32 v22, v22
v_exp_f32 v23, v23
v_mul_f32 v37, v37, v43
v_mul_f32 v32, v32, v43
v_mul_f32 v33, v33, v43
v_mul_f32 v34, v34, v43
v_mul_f32 v35, v35, v43
v_add_f32 v44, v16, v17
v_add_f32 v45, v18, v19
v_add_f32 v44, v44, v20
v_add_f32 v45, v45, v21
v_add_f32 v44, v44, v22
v_add_f32 v45, v45, v23
v_add_f32 v37, v37, v44
v_add_f32 v37, v37, v45
v_cvt_pk_bf16_f32 v16, v16, v17
v_cvt_pk_bf16_f32 v17, v18, v19
v_cvt_pk_bf16_f32 v18, v20, v21
v_cvt_pk_bf16_f32 v19, v22, v23
s_cmp_eq_u32 s83, 0
s_nop 0
s_cbranch_scc1 Lsk_22
s_waitcnt vmcnt(12)
ds_read_b64_tr_b16 a[64:65], v41 offset:0
v_xor_b32 v46, 32, v41
ds_read_b64_tr_b16 a[72:73], v46 offset:0
v_xor_b32 v47, 64, v41
ds_read_b64_tr_b16 a[80:81], v47 offset:0
v_xor_b32 v46, 96, v41
ds_read_b64_tr_b16 a[88:89], v46 offset:0
v_xor_b32 v47, 128, v41
ds_read_b64_tr_b16 a[96:97], v47 offset:0
v_xor_b32 v46, 160, v41
ds_read_b64_tr_b16 a[104:105], v46 offset:0
v_xor_b32 v47, 192, v41
ds_read_b64_tr_b16 a[112:113], v47 offset:0
v_xor_b32 v46, 224, v41
ds_read_b64_tr_b16 a[120:121], v46 offset:0
s_waitcnt lgkmcnt(0)
s_add_u32 m0, s90, 16384
s_nop 0
buffer_load_dwordx4 v38, s[12:15], s37 offen offset:0 nt lds
buffer_load_dwordx4 v39, s[12:15], s37 offen offset:1024 nt lds
buffer_load_dwordx4 v38, s[12:15], s37 offen offset:2048 nt lds
buffer_load_dwordx4 v39, s[12:15], s37 offen offset:3072 nt lds
s_waitcnt vmcnt(12)
ds_read_b64_tr_b16 a[66:67], v41 offset:4096
v_xor_b32 v46, 32, v41
ds_read_b64_tr_b16 a[74:75], v46 offset:4096
v_xor_b32 v47, 64, v41
ds_read_b64_tr_b16 a[82:83], v47 offset:4096
v_xor_b32 v46, 96, v41
ds_read_b64_tr_b16 a[90:91], v46 offset:4096
v_xor_b32 v47, 128, v41
ds_read_b64_tr_b16 a[98:99], v47 offset:4096
v_xor_b32 v46, 160, v41
ds_read_b64_tr_b16 a[106:107], v46 offset:4096
v_xor_b32 v47, 192, v41
ds_read_b64_tr_b16 a[114:115], v47 offset:4096
v_xor_b32 v46, 224, v41
ds_read_b64_tr_b16 a[122:123], v46 offset:4096
s_waitcnt lgkmcnt(0)
s_add_u32 s88, s37, 4096
s_mov_b32 m0, s90
s_nop 0
buffer_load_dwordx4 v38, s[12:15], s88 offen offset:0 nt lds
buffer_load_dwordx4 v39, s[12:15], s88 offen offset:1024 nt lds
buffer_load_dwordx4 v38, s[12:15], s88 offen offset:2048 nt lds
buffer_load_dwordx4 v39, s[12:15], s88 offen offset:3072 nt lds
Lsk_22:
v_cndmask_b32_e64 v24, 0, v16, s[16:17]
v_cndmask_b32_e64 v25, 0, v17, s[16:17]
v_cndmask_b32_e64 v26, 0, v18, s[16:17]
v_cndmask_b32_e64 v27, 0, v19, s[16:17]
v_cndmask_b32_e64 v28, 0, v16, s[18:19]
v_cndmask_b32_e64 v29, 0, v17, s[18:19]
v_cndmask_b32_e64 v30, 0, v18, s[18:19]
v_cndmask_b32_e64 v31, 0, v19, s[18:19]
v_mfma_f32_16x16x32_bf16 v[32:35], a[64:67], v[24:27], v[32:35]
v_cndmask_b32_e64 v24, 0, v16, s[20:21]
v_cndmask_b32_e64 v25, 0, v17, s[20:21]
v_cndmask_b32_e64 v26, 0, v18, s[20:21]
v_cndmask_b32_e64 v27, 0, v19, s[20:21]
v_mfma_f32_16x16x32_bf16 v[32:35], a[72:75], v[28:31], v[32:35]
v_cndmask_b32_e64 v28, 0, v16, s[22:23]
v_cndmask_b32_e64 v29, 0, v17, s[22:23]
v_cndmask_b32_e64 v30, 0, v18, s[22:23]
v_cndmask_b32_e64 v31, 0, v19, s[22:23]
v_mfma_f32_16x16x32_bf16 v[32:35], a[80:83], v[24:27], v[32:35]
v_cndmask_b32_e64 v24, 0, v16, s[24:25]
v_cndmask_b32_e64 v25, 0, v17, s[24:25]
v_cndmask_b32_e64 v26, 0, v18, s[24:25]
v_cndmask_b32_e64 v27, 0, v19, s[24:25]
v_mfma_f32_16x16x32_bf16 v[32:35], a[88:91], v[28:31], v[32:35]
v_cndmask_b32_e64 v28, 0, v16, s[26:27]
v_cndmask_b32_e64 v29, 0, v17, s[26:27]
v_cndmask_b32_e64 v30, 0, v18, s[26:27]
v_cndmask_b32_e64 v31, 0, v19, s[26:27]
v_mfma_f32_16x16x32_bf16 v[32:35], a[96:99], v[24:27], v[32:35]
v_cndmask_b32_e64 v24, 0, v16, s[28:29]
v_cndmask_b32_e64 v25, 0, v17, s[28:29]
v_cndmask_b32_e64 v26, 0, v18, s[28:29]
v_cndmask_b32_e64 v27, 0, v19, s[28:29]
v_mfma_f32_16x16x32_bf16 v[32:35], a[104:107], v[28:31], v[32:35]
v_cndmask_b32_e64 v28, 0, v16, s[30:31]
v_cndmask_b32_e64 v29, 0, v17, s[30:31]
v_cndmask_b32_e64 v30, 0, v18, s[30:31]
v_cndmask_b32_e64 v31, 0, v19, s[30:31]
v_mfma_f32_16x16x32_bf16 v[32:35], a[112:115], v[24:27], v[32:35]
s_nop 0
v_mfma_f32_16x16x32_bf16 v[32:35], a[120:123], v[28:31], v[32:35]
s_waitcnt vmcnt(12)
ds_read_b128 v[144:147], v40 offset:8192
v_xor_b32 v46, 64, v40
ds_read_b128 v[148:151], v46 offset:8192
v_xor_b32 v47, 128, v40
ds_read_b128 v[152:155], v47 offset:8192
v_xor_b32 v46, 192, v40
ds_read_b128 v[156:159], v46 offset:8192
s_waitcnt lgkmcnt(0)
s_add_u32 m0, s90, 4096
s_nop 0
buffer_load_dwordx4 v38, s[8:11], s38 offen offset:0 nt lds
buffer_load_dwordx4 v39, s[8:11], s38 offen offset:1024 nt lds
buffer_load_dwordx4 v38, s[8:11], s38 offen offset:2048 nt lds
buffer_load_dwordx4 v39, s[8:11], s38 offen offset:3072 nt lds
s_waitcnt vmcnt(12)
ds_read_b128 v[160:163], v40 offset:12288
v_xor_b32 v46, 64, v40
ds_read_b128 v[164:167], v46 offset:12288
v_xor_b32 v47, 128, v40
ds_read_b128 v[168:171], v47 offset:12288
v_xor_b32 v46, 192, v40
ds_read_b128 v[172:175], v46 offset:12288
s_waitcnt lgkmcnt(0)
s_add_u32 s88, s38, 4096
s_add_u32 m0, s90, 8192
s_nop 0
buffer_load_dwordx4 v38, s[8:11], s88 offen offset:0 nt lds
buffer_load_dwordx4 v39, s[8:11], s88 offen offset:1024 nt lds
buffer_load_dwordx4 v38, s[8:11], s88 offen offset:2048 nt lds
buffer_load_dwordx4 v39, s[8:11], s88 offen offset:3072 nt lds
v_mfma_f32_16x16x32_bf16 v[16:19], v[144:147], v[0:3], 0
v_mfma_f32_16x16x32_bf16 v[20:23], v[160:163], v[0:3], 0
v_mfma_f32_16x16x32_bf16 v[16:19], v[148:151], v[4:7], v[16:19]
v_mfma_f32_16x16x32_bf16 v[20:23], v[164:167], v[4:7], v[20:23]
v_mfma_f32_16x16x32_bf16 v[16:19], v[152:155], v[8:11], v[16:19]
v_mfma_f32_16x16x32_bf16 v[20:23], v[168:171], v[8:11], v[20:23]
v_mfma_f32_16x16x32_bf16 v[16:19], v[156:159], v[12:15], v[16:19]
v_mfma_f32_16x16x32_bf16 v[20:23], v[172:175], v[12:15], v[20:23]
s_nop 6
v_max3_f32 v42, v16, v17, v18
v_max3_f32 v43, v20, v21, v22
v_max3_f32 v42, v42, v19, v23
v_max3_f32 v42, v42, v43, v36
v_mov_b32 v43, v42
s_nop 1
v_permlane16_swap_b32 v42, v43
v_max_f32 v42, v42, v43
v_mov_b32 v43, v42
s_nop 1
v_permlane32_swap_b32 v42, v43
v_max_f32 v42, v42, v43
v_sub_f32 v43, v36, v42
v_exp_f32 v43, v43
v_mov_b32 v36, v42
v_sub_f32 v16, v16, v42
v_sub_f32 v17, v17, v42
v_sub_f32 v18, v18, v42
v_sub_f32 v19, v19, v42
v_sub_f32 v20, v20, v42
v_sub_f32 v21, v21, v42
v_sub_f32 v22, v22, v42
v_sub_f32 v23, v23, v42
v_exp_f32 v16, v16
v_exp_f32 v17, v17
v_exp_f32 v18, v18
v_exp_f32 v19, v19
v_exp_f32 v20, v20
v_exp_f32 v21, v21
v_exp_f32 v22, v22
v_exp_f32 v23, v23
v_mul_f32 v37, v37, v43
v_mul_f32 v32, v32, v43
v_mul_f32 v33, v33, v43
v_mul_f32 v34, v34, v43
v_mul_f32 v35, v35, v43
v_add_f32 v44, v16, v17
v_add_f32 v45, v18, v19
v_add_f32 v44, v44, v20
v_add_f32 v45, v45, v21
v_add_f32 v44, v44, v22
v_add_f32 v45, v45, v23
v_add_f32 v37, v37, v44
v_add_f32 v37, v37, v45
v_cvt_pk_bf16_f32 v16, v16, v17
v_cvt_pk_bf16_f32 v17, v18, v19
v_cvt_pk_bf16_f32 v18, v20, v21
v_cvt_pk_bf16_f32 v19, v22, v23
s_waitcnt vmcnt(12)
ds_read_b64_tr_b16 a[68:69], v41 offset:16384
v_xor_b32 v46, 32, v41
ds_read_b64_tr_b16 a[76:77], v46 offset:16384
v_xor_b32 v47, 64, v41
ds_read_b64_tr_b16 a[84:85], v47 offset:16384
v_xor_b32 v46, 96, v41
ds_read_b64_tr_b16 a[92:93], v46 offset:16384
v_xor_b32 v47, 128, v41
ds_read_b64_tr_b16 a[100:101], v47 offset:16384
v_xor_b32 v46, 160, v41
ds_read_b64_tr_b16 a[108:109], v46 offset:16384
v_xor_b32 v47, 192, v41
ds_read_b64_tr_b16 a[116:117], v47 offset:16384
v_xor_b32 v46, 224, v41
ds_read_b64_tr_b16 a[124:125], v46 offset:16384
s_waitcnt lgkmcnt(0)
s_add_u32 m0, s90, 12288
s_nop 0
buffer_load_dwordx4 v38, s[12:15], s38 offen offset:0 nt lds
buffer_load_dwordx4 v39, s[12:15], s38 offen offset:1024 nt lds
buffer_load_dwordx4 v38, s[12:15], s38 offen offset:2048 nt lds
buffer_load_dwordx4 v39, s[12:15], s38 offen offset:3072 nt lds
s_waitcnt vmcnt(12)
ds_read_b64_tr_b16 a[70:71], v41 offset:0
v_xor_b32 v46, 32, v41
ds_read_b64_tr_b16 a[78:79], v46 offset:0
v_xor_b32 v47, 64, v41
ds_read_b64_tr_b16 a[86:87], v47 offset:0
v_xor_b32 v46, 96, v41
ds_read_b64_tr_b16 a[94:95], v46 offset:0
v_xor_b32 v47, 128, v41
ds_read_b64_tr_b16 a[102:103], v47 offset:0
v_xor_b32 v46, 160, v41
ds_read_b64_tr_b16 a[110:111], v46 offset:0
v_xor_b32 v47, 192, v41
ds_read_b64_tr_b16 a[118:119], v47 offset:0
v_xor_b32 v46, 224, v41
ds_read_b64_tr_b16 a[126:127], v46 offset:0
s_waitcnt lgkmcnt(0)
s_add_u32 s88, s38, 4096
s_add_u32 m0, s90, 16384
s_nop 0
buffer_load_dwordx4 v38, s[12:15], s88 offen offset:0 nt lds
buffer_load_dwordx4 v39, s[12:15], s88 offen offset:1024 nt lds
buffer_load_dwordx4 v38, s[12:15], s88 offen offset:2048 nt lds
buffer_load_dwordx4 v39, s[12:15], s88 offen offset:3072 nt lds
v_cndmask_b32_e64 v24, 0, v16, s[16:17]
v_cndmask_b32_e64 v25, 0, v17, s[16:17]
v_cndmask_b32_e64 v26, 0, v18, s[16:17]
v_cndmask_b32_e64 v27, 0, v19, s[16:17]
v_cndmask_b32_e64 v28, 0, v16, s[18:19]
v_cndmask_b32_e64 v29, 0, v17, s[18:19]
v_cndmask_b32_e64 v30, 0, v18, s[18:19]
v_cndmask_b32_e64 v31, 0, v19, s[18:19]
v_mfma_f32_16x16x32_bf16 v[32:35], a[68:71], v[24:27], v[32:35]
v_cndmask_b32_e64 v24, 0, v16, s[20:21]
v_cndmask_b32_e64 v25, 0, v17, s[20:21]
v_cndmask_b32_e64 v26, 0, v18, s[20:21]
v_cndmask_b32_e64 v27, 0, v19, s[20:21]
v_mfma_f32_16x16x32_bf16 v[32:35], a[76:79], v[28:31], v[32:35]
v_cndmask_b32_e64 v28, 0, v16, s[22:23]
v_cndmask_b32_e64 v29, 0, v17, s[22:23]
v_cndmask_b32_e64 v30, 0, v18, s[22:23]
v_cndmask_b32_e64 v31, 0, v19, s[22:23]
v_mfma_f32_16x16x32_bf16 v[32:35], a[84:87], v[24:27], v[32:35]
v_cndmask_b32_e64 v24, 0, v16, s[24:25]
v_cndmask_b32_e64 v25, 0, v17, s[24:25]
v_cndmask_b32_e64 v26, 0, v18, s[24:25]
v_cndmask_b32_e64 v27, 0, v19, s[24:25]
v_mfma_f32_16x16x32_bf16 v[32:35], a[92:95], v[28:31], v[32:35]
v_cndmask_b32_e64 v28, 0, v16, s[26:27]
v_cndmask_b32_e64 v29, 0, v17, s[26:27]
v_cndmask_b32_e64 v30, 0, v18, s[26:27]
v_cndmask_b32_e64 v31, 0, v19, s[26:27]
v_mfma_f32_16x16x32_bf16 v[32:35], a[100:103], v[24:27], v[32:35]
v_cndmask_b32_e64 v24, 0, v16, s[28:29]
v_cndmask_b32_e64 v25, 0, v17, s[28:29]
v_cndmask_b32_e64 v26, 0, v18, s[28:29]
v_cndmask_b32_e64 v27, 0, v19, s[28:29]
v_mfma_f32_16x16x32_bf16 v[32:35], a[108:111], v[28:31], v[32:35]
v_cndmask_b32_e64 v28, 0, v16, s[30:31]
v_cndmask_b32_e64 v29, 0, v17, s[30:31]
v_cndmask_b32_e64 v30, 0, v18, s[30:31]
v_cndmask_b32_e64 v31, 0, v19, s[30:31]
v_mfma_f32_16x16x32_bf16 v[32:35], a[116:119], v[24:27], v[32:35]
s_nop 0
v_mfma_f32_16x16x32_bf16 v[32:35], a[124:127], v[28:31], v[32:35]
s_waitcnt vmcnt(12)
ds_read_b128 v[176:179], v40 offset:4096
v_xor_b32 v46, 64, v40
ds_read_b128 v[180:183], v46 offset:4096
v_xor_b32 v47, 128, v40
ds_read_b128 v[184:187], v47 offset:4096
v_xor_b32 v46, 192, v40
ds_read_b128 v[188:191], v46 offset:4096
s_waitcnt lgkmcnt(0)
s_mov_b32 m0, s90
s_nop 0
buffer_load_dwordx4 v38, s[8:11], s39 offen offset:0 nt lds
buffer_load_dwordx4 v39, s[8:11], s39 offen offset:1024 nt lds
buffer_load_dwordx4 v38, s[8:11], s39 offen offset:2048 nt lds
buffer_load_dwordx4 v39, s[8:11], s39 offen offset:3072 nt lds
s_waitcnt vmcnt(12)
ds_read_b128 v[192:195], v40 offset:8192
v_xor_b32 v46, 64, v40
ds_read_b128 v[196:199], v46 offset:8192
v_xor_b32 v47, 128, v40
ds_read_b128 v[200:203], v47 offset:8192
v_xor_b32 v46, 192, v40
ds_read_b128 v[204:207], v46 offset:8192
s_waitcnt lgkmcnt(0)
s_add_u32 s88, s39, 4096
s_add_u32 m0, s90, 4096
s_nop 0
buffer_load_dwordx4 v38, s[8:11], s88 offen offset:0 nt lds
buffer_load_dwordx4 v39, s[8:11], s88 offen offset:1024 nt lds
buffer_load_dwordx4 v38, s[8:11], s88 offen offset:2048 nt lds
buffer_load_dwordx4 v39, s[8:11], s88 offen offset:3072 nt lds
v_mfma_f32_16x16x32_bf16 v[16:19], v[176:179], v[0:3], 0
v_mfma_f32_16x16x32_bf16 v[20:23], v[192:195], v[0:3], 0
v_mfma_f32_16x16x32_bf16 v[16:19], v[180:183], v[4:7], v[16:19]
v_mfma_f32_16x16x32_bf16 v[20:23], v[196:199], v[4:7], v[20:23]
v_mfma_f32_16x16x32_bf16 v[16:19], v[184:187], v[8:11], v[16:19]
v_mfma_f32_16x16x32_bf16 v[20:23], v[200:203], v[8:11], v[20:23]
v_mfma_f32_16x16x32_bf16 v[16:19], v[188:191], v[12:15], v[16:19]
v_mfma_f32_16x16x32_bf16 v[20:23], v[204:207], v[12:15], v[20:23]
s_nop 6
v_max3_f32 v42, v16, v17, v18
v_max3_f32 v43, v20, v21, v22
v_max3_f32 v42, v42, v19, v23
v_max3_f32 v42, v42, v43, v36
v_mov_b32 v43, v42
s_nop 1
v_permlane16_swap_b32 v42, v43
v_max_f32 v42, v42, v43
v_mov_b32 v43, v42
s_nop 1
v_permlane32_swap_b32 v42, v43
v_max_f32 v42, v42, v43
v_sub_f32 v43, v36, v42
v_exp_f32 v43, v43
v_mov_b32 v36, v42
v_sub_f32 v16, v16, v42
v_sub_f32 v17, v17, v42
v_sub_f32 v18, v18, v42
v_sub_f32 v19, v19, v42
v_sub_f32 v20, v20, v42
v_sub_f32 v21, v21, v42
v_sub_f32 v22, v22, v42
v_sub_f32 v23, v23, v42
v_exp_f32 v16, v16
v_exp_f32 v17, v17
v_exp_f32 v18, v18
v_exp_f32 v19, v19
v_exp_f32 v20, v20
v_exp_f32 v21, v21
v_exp_f32 v22, v22
v_exp_f32 v23, v23
v_mul_f32 v37, v37, v43
v_mul_f32 v32, v32, v43
v_mul_f32 v33, v33, v43
v_mul_f32 v34, v34, v43
v_mul_f32 v35, v35, v43
v_add_f32 v44, v16, v17
v_add_f32 v45, v18, v19
v_add_f32 v44, v44, v20
v_add_f32 v45, v45, v21
v_add_f32 v44, v44, v22
v_add_f32 v45, v45, v23
v_add_f32 v37, v37, v44
v_add_f32 v37, v37, v45
v_cvt_pk_bf16_f32 v16, v16, v17
v_cvt_pk_bf16_f32 v17, v18, v19
v_cvt_pk_bf16_f32 v18, v20, v21
v_cvt_pk_bf16_f32 v19, v22, v23
s_waitcnt vmcnt(12)
ds_read_b64_tr_b16 a[128:129], v41 offset:12288
v_xor_b32 v46, 32, v41
ds_read_b64_tr_b16 a[136:137], v46 offset:12288
v_xor_b32 v47, 64, v41
ds_read_b64_tr_b16 a[144:145], v47 offset:12288
v_xor_b32 v46, 96, v41
ds_read_b64_tr_b16 a[152:153], v46 offset:12288
v_xor_b32 v47, 128, v41
ds_read_b64_tr_b16 a[160:161], v47 offset:12288
v_xor_b32 v46, 160, v41
ds_read_b64_tr_b16 a[168:169], v46 offset:12288
v_xor_b32 v47, 192, v41
ds_read_b64_tr_b16 a[176:177], v47 offset:12288
v_xor_b32 v46, 224, v41
ds_read_b64_tr_b16 a[184:185], v46 offset:12288
s_waitcnt lgkmcnt(0)
s_add_u32 m0, s90, 8192
s_nop 0
buffer_load_dwordx4 v38, s[12:15], s39 offen offset:0 nt lds
buffer_load_dwordx4 v39, s[12:15], s39 offen offset:1024 nt lds
buffer_load_dwordx4 v38, s[12:15], s39 offen offset:2048 nt lds
buffer_load_dwordx4 v39, s[12:15], s39 offen offset:3072 nt lds
s_waitcnt vmcnt(12)
ds_read_b64_tr_b16 a[130:131], v41 offset:16384
v_xor_b32 v46, 32, v41
ds_read_b64_tr_b16 a[138:139], v46 offset:16384
v_xor_b32 v47, 64, v41
ds_read_b64_tr_b16 a[146:147], v47 offset:16384
v_xor_b32 v46, 96, v41
ds_read_b64_tr_b16 a[154:155], v46 offset:16384
v_xor_b32 v47, 128, v41
ds_read_b64_tr_b16 a[162:163], v47 offset:16384
v_xor_b32 v46, 160, v41
ds_read_b64_tr_b16 a[170:171], v46 offset:16384
v_xor_b32 v47, 192, v41
ds_read_b64_tr_b16 a[178:179], v47 offset:16384
v_xor_b32 v46, 224, v41
ds_read_b64_tr_b16 a[186:187], v46 offset:16384
s_waitcnt lgkmcnt(0)
s_add_u32 s88, s39, 4096
s_add_u32 m0, s90, 12288
s_nop 0
buffer_load_dwordx4 v38, s[12:15], s88 offen offset:0 nt lds
buffer_load_dwordx4 v39, s[12:15], s88 offen offset:1024 nt lds
buffer_load_dwordx4 v38, s[12:15], s88 offen offset:2048 nt lds
buffer_load_dwordx4 v39, s[12:15], s88 offen offset:3072 nt lds
v_cndmask_b32_e64 v24, 0, v16, s[16:17]
v_cndmask_b32_e64 v25, 0, v17, s[16:17]
v_cndmask_b32_e64 v26, 0, v18, s[16:17]
v_cndmask_b32_e64 v27, 0, v19, s[16:17]
v_cndmask_b32_e64 v28, 0, v16, s[18:19]
v_cndmask_b32_e64 v29, 0, v17, s[18:19]
v_cndmask_b32_e64 v30, 0, v18, s[18:19]
v_cndmask_b32_e64 v31, 0, v19, s[18:19]
v_mfma_f32_16x16x32_bf16 v[32:35], a[128:131], v[24:27], v[32:35]
v_cndmask_b32_e64 v24, 0, v16, s[20:21]
v_cndmask_b32_e64 v25, 0, v17, s[20:21]
v_cndmask_b32_e64 v26, 0, v18, s[20:21]
v_cndmask_b32_e64 v27, 0, v19, s[20:21]
v_mfma_f32_16x16x32_bf16 v[32:35], a[136:139], v[28:31], v[32:35]
v_cndmask_b32_e64 v28, 0, v16, s[22:23]
v_cndmask_b32_e64 v29, 0, v17, s[22:23]
v_cndmask_b32_e64 v30, 0, v18, s[22:23]
v_cndmask_b32_e64 v31, 0, v19, s[22:23]
v_mfma_f32_16x16x32_bf16 v[32:35], a[144:147], v[24:27], v[32:35]
v_cndmask_b32_e64 v24, 0, v16, s[24:25]
v_cndmask_b32_e64 v25, 0, v17, s[24:25]
v_cndmask_b32_e64 v26, 0, v18, s[24:25]
v_cndmask_b32_e64 v27, 0, v19, s[24:25]
v_mfma_f32_16x16x32_bf16 v[32:35], a[152:155], v[28:31], v[32:35]
v_cndmask_b32_e64 v28, 0, v16, s[26:27]
v_cndmask_b32_e64 v29, 0, v17, s[26:27]
v_cndmask_b32_e64 v30, 0, v18, s[26:27]
v_cndmask_b32_e64 v31, 0, v19, s[26:27]
v_mfma_f32_16x16x32_bf16 v[32:35], a[160:163], v[24:27], v[32:35]
v_cndmask_b32_e64 v24, 0, v16, s[28:29]
v_cndmask_b32_e64 v25, 0, v17, s[28:29]
v_cndmask_b32_e64 v26, 0, v18, s[28:29]
v_cndmask_b32_e64 v27, 0, v19, s[28:29]
v_mfma_f32_16x16x32_bf16 v[32:35], a[168:171], v[28:31], v[32:35]
v_cndmask_b32_e64 v28, 0, v16, s[30:31]
v_cndmask_b32_e64 v29, 0, v17, s[30:31]
v_cndmask_b32_e64 v30, 0, v18, s[30:31]
v_cndmask_b32_e64 v31, 0, v19, s[30:31]
v_mfma_f32_16x16x32_bf16 v[32:35], a[176:179], v[24:27], v[32:35]
s_nop 0
v_mfma_f32_16x16x32_bf16 v[32:35], a[184:187], v[28:31], v[32:35]
s_waitcnt vmcnt(12)
ds_read_b128 v[208:211], v40 offset:0
v_xor_b32 v46, 64, v40
ds_read_b128 v[212:215], v46 offset:0
v_xor_b32 v47, 128, v40
ds_read_b128 v[216:219], v47 offset:0
v_xor_b32 v46, 192, v40
ds_read_b128 v[220:223], v46 offset:0
s_waitcnt lgkmcnt(0)
s_cmp_eq_u32 s85, 0
s_cbranch_scc1 Lsk_23
s_mov_b32 m0, s90
s_nop 0
buffer_load_dwordx4 v38, s[8:11], s40 offen offset:0 nt lds
buffer_load_dwordx4 v39, s[8:11], s40 offen offset:1024 nt lds
buffer_load_dwordx4 v38, s[8:11], s40 offen offset:2048 nt lds
buffer_load_dwordx4 v39, s[8:11], s40 offen offset:3072 nt lds
Lsk_23:
s_cmp_eq_u32 s83, 0
s_cbranch_scc1 Ldq_24
s_waitcnt vmcnt(8)
Ldq_24:
s_waitcnt vmcnt(12)
ds_read_b128 v[224:227], v40 offset:4096
v_xor_b32 v46, 64, v40
ds_read_b128 v[228:231], v46 offset:4096
v_xor_b32 v47, 128, v40
ds_read_b128 v[232:235], v47 offset:4096
v_xor_b32 v46, 192, v40
ds_read_b128 v[236:239], v46 offset:4096
s_waitcnt lgkmcnt(0)
s_cmp_eq_u32 s85, 0
s_cbranch_scc1 Lsk_25
s_add_u32 m0, s90, 4096
s_nop 0
buffer_load_dwordx4 v38, s[12:15], s40 offen offset:0 nt lds
buffer_load_dwordx4 v39, s[12:15], s40 offen offset:1024 nt lds
buffer_load_dwordx4 v38, s[12:15], s40 offen offset:2048 nt lds
buffer_load_dwordx4 v39, s[12:15], s40 offen offset:3072 nt lds
Lsk_25:
v_mfma_f32_16x16x32_bf16 v[16:19], v[208:211], v[0:3], 0
v_mfma_f32_16x16x32_bf16 v[20:23], v[224:227], v[0:3], 0
v_mfma_f32_16x16x32_bf16 v[16:19], v[212:215], v[4:7], v[16:19]
v_mfma_f32_16x16x32_bf16 v[20:23], v[228:231], v[4:7], v[20:23]
v_mfma_f32_16x16x32_bf16 v[16:19], v[216:219], v[8:11], v[16:19]
v_mfma_f32_16x16x32_bf16 v[20:23], v[232:235], v[8:11], v[20:23]
v_mfma_f32_16x16x32_bf16 v[16:19], v[220:223], v[12:15], v[16:19]
v_mfma_f32_16x16x32_bf16 v[20:23], v[236:239], v[12:15], v[20:23]
s_nop 6
v_max3_f32 v42, v16, v17, v18
v_max3_f32 v43, v20, v21, v22
v_max3_f32 v42, v42, v19, v23
v_max3_f32 v42, v42, v43, v36
v_mov_b32 v43, v42
s_nop 1
v_permlane16_swap_b32 v42, v43
v_max_f32 v42, v42, v43
v_mov_b32 v43, v42
s_nop 1
v_permlane32_swap_b32 v42, v43
v_max_f32 v42, v42, v43
v_sub_f32 v43, v36, v42
v_exp_f32 v43, v43
v_mov_b32 v36, v42
v_sub_f32 v16, v16, v42
v_sub_f32 v17, v17, v42
v_sub_f32 v18, v18, v42
v_sub_f32 v19, v19, v42
v_sub_f32 v20, v20, v42
v_sub_f32 v21, v21, v42
v_sub_f32 v22, v22, v42
v_sub_f32 v23, v23, v42
v_exp_f32 v16, v16
v_exp_f32 v17, v17
v_exp_f32 v18, v18
v_exp_f32 v19, v19
v_exp_f32 v20, v20
v_exp_f32 v21, v21
v_exp_f32 v22, v22
v_exp_f32 v23, v23
v_mul_f32 v37, v37, v43
v_mul_f32 v32, v32, v43
v_mul_f32 v33, v33, v43
v_mul_f32 v34, v34, v43
v_mul_f32 v35, v35, v43
v_add_f32 v44, v16, v17
v_add_f32 v45, v18, v19
v_add_f32 v44, v44, v20
v_add_f32 v45, v45, v21
v_add_f32 v44, v44, v22
v_add_f32 v45, v45, v23
v_add_f32 v37, v37, v44
v_add_f32 v37, v37, v45
v_cvt_pk_bf16_f32 v16, v16, v17
v_cvt_pk_bf16_f32 v17, v18, v19
v_cvt_pk_bf16_f32 v18, v20, v21
v_cvt_pk_bf16_f32 v19, v22, v23
s_cmp_eq_u32 s83, 0
s_nop 0
s_cbranch_scc1 Ldq_26
s_waitcnt vmcnt(4)
Ldq_26:
s_waitcnt vmcnt(12)
ds_read_b64_tr_b16 a[132:133], v41 offset:8192
v_xor_b32 v46, 32, v41
ds_read_b64_tr_b16 a[140:141], v46 offset:8192
v_xor_b32 v47, 64, v41
ds_read_b64_tr_b16 a[148:149], v47 offset:8192
v_xor_b32 v46, 96, v41
ds_read_b64_tr_b16 a[156:157], v46 offset:8192
v_xor_b32 v47, 128, v41
ds_read_b64_tr_b16 a[164:165], v47 offset:8192
v_xor_b32 v46, 160, v41
ds_read_b64_tr_b16 a[172:173], v46 offset:8192
v_xor_b32 v47, 192, v41
ds_read_b64_tr_b16 a[180:181], v47 offset:8192
v_xor_b32 v46, 224, v41
ds_read_b64_tr_b16 a[188:189], v46 offset:8192
s_waitcnt lgkmcnt(0)
s_cmp_eq_u32 s85, 0
s_cbranch_scc1 Lsk_27
s_add_u32 s88, s40, 4096
s_add_u32 m0, s90, 8192
s_nop 0
buffer_load_dwordx4 v38, s[8:11], s88 offen offset:0 nt lds
buffer_load_dwordx4 v39, s[8:11], s88 offen offset:1024 nt lds
buffer_load_dwordx4 v38, s[8:11], s88 offen offset:2048 nt lds
buffer_load_dwordx4 v39, s[8:11], s88 offen offset:3072 nt lds
Lsk_27:
s_cmp_eq_u32 s83, 0
s_cbranch_scc1 Ldq_28
s_waitcnt vmcnt(0)
Ldq_28:
s_waitcnt vmcnt(12)
ds_read_b64_tr_b16 a[134:135], v41 offset:12288
v_xor_b32 v46, 32, v41
ds_read_b64_tr_b16 a[142:143], v46 offset:12288
v_xor_b32 v47, 64, v41
ds_read_b64_tr_b16 a[150:151], v47 offset:12288
v_xor_b32 v46, 96, v41
ds_read_b64_tr_b16 a[158:159], v46 offset:12288
v_xor_b32 v47, 128, v41
ds_read_b64_tr_b16 a[166:167], v47 offset:12288
v_xor_b32 v46, 160, v41
ds_read_b64_tr_b16 a[174:175], v46 offset:12288
v_xor_b32 v47, 192, v41
ds_read_b64_tr_b16 a[182:183], v47 offset:12288
v_xor_b32 v46, 224, v41
ds_read_b64_tr_b16 a[190:191], v46 offset:12288
s_waitcnt lgkmcnt(0)
s_cmp_eq_u32 s85, 0
s_cbranch_scc1 Lsk_29
s_add_u32 s88, s40, 4096
s_add_u32 m0, s90, 12288
s_nop 0
buffer_load_dwordx4 v38, s[12:15], s88 offen offset:0 nt lds
buffer_load_dwordx4 v39, s[12:15], s88 offen offset:1024 nt lds
buffer_load_dwordx4 v38, s[12:15], s88 offen offset:2048 nt lds
buffer_load_dwordx4 v39, s[12:15], s88 offen offset:3072 nt lds
Lsk_29:
s_cmp_eq_u32 s85, 0
s_cbranch_scc1 Lsk_30
s_add_u32 s88, s41, 4096
s_add_u32 m0, s90, 16384
s_nop 0
buffer_load_dwordx4 v38, s[8:11], s88 offen offset:0 nt lds
buffer_load_dwordx4 v39, s[8:11], s88 offen offset:1024 nt lds
buffer_load_dwordx4 v38, s[8:11], s88 offen offset:2048 nt lds
buffer_load_dwordx4 v39, s[8:11], s88 offen offset:3072 nt lds
Lsk_30:
v_cndmask_b32_e64 v24, 0, v16, s[16:17]
v_cndmask_b32_e64 v25, 0, v17, s[16:17]
v_cndmask_b32_e64 v26, 0, v18, s[16:17]
v_cndmask_b32_e64 v27, 0, v19, s[16:17]
v_cndmask_b32_e64 v28, 0, v16, s[18:19]
v_cndmask_b32_e64 v29, 0, v17, s[18:19]
v_cndmask_b32_e64 v30, 0, v18, s[18:19]
v_cndmask_b32_e64 v31, 0, v19, s[18:19]
v_mfma_f32_16x16x32_bf16 v[32:35], a[132:135], v[24:27], v[32:35]
v_cndmask_b32_e64 v24, 0, v16, s[20:21]
v_cndmask_b32_e64 v25, 0, v17, s[20:21]
v_cndmask_b32_e64 v26, 0, v18, s[20:21]
v_cndmask_b32_e64 v27, 0, v19, s[20:21]
v_mfma_f32_16x16x32_bf16 v[32:35], a[140:143], v[28:31], v[32:35]
v_cndmask_b32_e64 v28, 0, v16, s[22:23]
v_cndmask_b32_e64 v29, 0, v17, s[22:23]
v_cndmask_b32_e64 v30, 0, v18, s[22:23]
v_cndmask_b32_e64 v31, 0, v19, s[22:23]
v_mfma_f32_16x16x32_bf16 v[32:35], a[148:151], v[24:27], v[32:35]
v_cndmask_b32_e64 v24, 0, v16, s[24:25]
v_cndmask_b32_e64 v25, 0, v17, s[24:25]
v_cndmask_b32_e64 v26, 0, v18, s[24:25]
v_cndmask_b32_e64 v27, 0, v19, s[24:25]
v_mfma_f32_16x16x32_bf16 v[32:35], a[156:159], v[28:31], v[32:35]
v_cndmask_b32_e64 v28, 0, v16, s[26:27]
v_cndmask_b32_e64 v29, 0, v17, s[26:27]
v_cndmask_b32_e64 v30, 0, v18, s[26:27]
v_cndmask_b32_e64 v31, 0, v19, s[26:27]
v_mfma_f32_16x16x32_bf16 v[32:35], a[164:167], v[24:27], v[32:35]
v_cndmask_b32_e64 v24, 0, v16, s[28:29]
v_cndmask_b32_e64 v25, 0, v17, s[28:29]
v_cndmask_b32_e64 v26, 0, v18, s[28:29]
v_cndmask_b32_e64 v27, 0, v19, s[28:29]
v_mfma_f32_16x16x32_bf16 v[32:35], a[172:175], v[28:31], v[32:35]
v_cndmask_b32_e64 v28, 0, v16, s[30:31]
v_cndmask_b32_e64 v29, 0, v17, s[30:31]
v_cndmask_b32_e64 v30, 0, v18, s[30:31]
v_cndmask_b32_e64 v31, 0, v19, s[30:31]
v_mfma_f32_16x16x32_bf16 v[32:35], a[180:183], v[24:27], v[32:35]
s_nop 0
v_mfma_f32_16x16x32_bf16 v[32:35], a[188:191], v[28:31], v[32:35]
s_cmp_eq_u32 s83, 0
s_nop 6
s_cbranch_scc1 Lsk_31
s_mov_b32 s92, 0
s_mov_b32 s87, 1
s_branch L_pub1
L_retA:
s_lshl_b32 s88, s83, 2
s_add_u32 s88, s88, 148520
v_mov_b32 v46, s88
v_mov_b32 v47, 1
s_mov_b32 exec_lo, 0x1
s_mov_b32 exec_hi, 0x0
ds_add_rtn_u32 v42, v46, v47
s_waitcnt lgkmcnt(0)
v_readfirstlane_b32 s88, v42
s_mov_b64 exec, -1
s_cmp_lg_u32 s88, 0
s_nop 2
s_cbranch_scc1 Lhww_32
v_mbcnt_lo_u32_b32 v46, -1, 0
v_mbcnt_hi_u32_b32 v46, -1, v46
v_mul_u32_u24 v46, 640, v46
s_mul_i32 s89, s80, 5120
s_mul_i32 s91, s92, 196608
s_add_u32 s89, s89, s91
s_add_u32 s89, s89, 8704
s_mov_b32 exec_lo, 0x7f
s_mov_b32 exec_hi, 0x0
Lhw_33:
buffer_load_dword v47, v46, s[4:7], s89 offen sc1
s_waitcnt vmcnt(0)
v_cmp_ne_u32 vcc, -1, v47
s_bcnt1_i32_b64 s91, vcc
s_cmp_ge_u32 s91, 7
s_cbranch_scc1 Lhwd_34
s_sub_u32 s81, s81, 1
s_cbranch_scc0 Lhw_33
s_mov_b32 s81, 0
Lhwd_34:
s_mov_b64 exec, -1
s_lshl_b32 s88, s83, 2
s_add_u32 s88, s88, 148528
v_mov_b32 v46, s88
v_mov_b32 v47, 1
ds_write_b32 v46, v47
s_nop 0
Lhww_32:
s_lshl_b32 s88, s83, 2
s_add_u32 s88, s88, 148528
v_mov_b32 v46, s88
s_nop 1
Lfw_35:
ds_read_b32 v47, v46
s_waitcnt lgkmcnt(0)
v_cmp_eq_u32 vcc, 0, v47
s_nop 1
s_cbranch_vccz Lfwd_36
s_sub_u32 s95, s95, 1
s_cbranch_scc0 Lfw_35
s_mov_b32 s95, 0
Lfwd_36:
s_mov_b32 m0, s90
s_nop 0
buffer_load_dwordx4 v38, s[8:11], s40 offen offset:0 nt lds
buffer_load_dwordx4 v39, s[8:11], s40 offen offset:1024 nt lds
buffer_load_dwordx4 v38, s[8:11], s40 offen offset:2048 nt lds
buffer_load_dwordx4 v39, s[8:11], s40 offen offset:3072 nt lds
s_add_u32 m0, s90, 4096
s_nop 0
buffer_load_dwordx4 v38, s[12:15], s40 offen offset:0 nt lds
buffer_load_dwordx4 v39, s[12:15], s40 offen offset:1024 nt lds
buffer_load_dwordx4 v38, s[12:15], s40 offen offset:2048 nt lds
buffer_load_dwordx4 v39, s[12:15], s40 offen offset:3072 nt lds
s_add_u32 s88, s40, 4096
s_add_u32 m0, s90, 8192
s_nop 0
buffer_load_dwordx4 v38, s[8:11], s88 offen offset:0 nt lds
buffer_load_dwordx4 v39, s[8:11], s88 offen offset:1024 nt lds
buffer_load_dwordx4 v38, s[8:11], s88 offen offset:2048 nt lds
buffer_load_dwordx4 v39, s[8:11], s88 offen offset:3072 nt lds
s_add_u32 s88, s40, 4096
s_add_u32 m0, s90, 12288
s_nop 0
buffer_load_dwordx4 v38, s[12:15], s88 offen offset:0 nt lds
buffer_load_dwordx4 v39, s[12:15], s88 offen offset:1024 nt lds
buffer_load_dwordx4 v38, s[12:15], s88 offen offset:2048 nt lds
buffer_load_dwordx4 v39, s[12:15], s88 offen offset:3072 nt lds
s_add_u32 s88, s41, 4096
s_add_u32 m0, s90, 16384
s_nop 0
buffer_load_dwordx4 v38, s[8:11], s88 offen offset:0 nt lds
buffer_load_dwordx4 v39, s[8:11], s88 offen offset:1024 nt lds
buffer_load_dwordx4 v38, s[8:11], s88 offen offset:2048 nt lds
buffer_load_dwordx4 v39, s[8:11], s88 offen offset:3072 nt lds
Lsk_31:
s_waitcnt vmcnt(16)
ds_read_b128 v[240:243], v40 offset:0
v_xor_b32 v46, 64, v40
ds_read_b128 v[244:247], v46 offset:0
v_xor_b32 v47, 128, v40
ds_read_b128 v[248:251], v47 offset:0
v_xor_b32 v46, 192, v40
ds_read_b128 v[252:255], v46 offset:0
s_waitcnt lgkmcnt(0)
s_mov_b32 m0, s90
s_nop 0
buffer_load_dwordx4 v38, s[12:15], s41 offen offset:0 nt lds
buffer_load_dwordx4 v39, s[12:15], s41 offen offset:1024 nt lds
buffer_load_dwordx4 v38, s[12:15], s41 offen offset:2048 nt lds
buffer_load_dwordx4 v39, s[12:15], s41 offen offset:3072 nt lds
s_waitcnt vmcnt(16)
ds_read_b64_tr_b16 a[192:193], v41 offset:4096
v_xor_b32 v46, 32, v41
ds_read_b64_tr_b16 a[200:201], v46 offset:4096
v_xor_b32 v47, 64, v41
ds_read_b64_tr_b16 a[208:209], v47 offset:4096
v_xor_b32 v46, 96, v41
ds_read_b64_tr_b16 a[216:217], v46 offset:4096
v_xor_b32 v47, 128, v41
ds_read_b64_tr_b16 a[224:225], v47 offset:4096
v_xor_b32 v46, 160, v41
ds_read_b64_tr_b16 a[232:233], v46 offset:4096
v_xor_b32 v47, 192, v41
ds_read_b64_tr_b16 a[240:241], v47 offset:4096
v_xor_b32 v46, 224, v41
ds_read_b64_tr_b16 a[248:249], v46 offset:4096
s_waitcnt lgkmcnt(0)
s_add_u32 s88, s41, 4096
s_add_u32 m0, s90, 4096
s_nop 0
buffer_load_dwordx4 v38, s[12:15], s88 offen offset:0 nt lds
buffer_load_dwordx4 v39, s[12:15], s88 offen offset:1024 nt lds
buffer_load_dwordx4 v38, s[12:15], s88 offen offset:2048 nt lds
buffer_load_dwordx4 v39, s[12:15], s88 offen offset:3072 nt lds
s_cmp_eq_u32 s85, 0
s_cbranch_scc1 Lsk_37
s_waitcnt vmcnt(16)
ds_read_b128 a[196:199], v40 offset:8192
v_xor_b32 v46, 64, v40
ds_read_b128 a[204:207], v46 offset:8192
v_xor_b32 v47, 128, v40
ds_read_b128 a[212:215], v47 offset:8192
v_xor_b32 v46, 192, v40
ds_read_b128 a[220:223], v46 offset:8192
s_waitcnt lgkmcnt(0)
v_mfma_f32_16x16x32_bf16 v[16:19], v[240:243], v[0:3], 0
v_mfma_f32_16x16x32_bf16 v[20:23], a[196:199], v[0:3], 0
v_mfma_f32_16x16x32_bf16 v[16:19], v[244:247], v[4:7], v[16:19]
v_mfma_f32_16x16x32_bf16 v[20:23], a[204:207], v[4:7], v[20:23]
v_mfma_f32_16x16x32_bf16 v[16:19], v[248:251], v[8:11], v[16:19]
v_mfma_f32_16x16x32_bf16 v[20:23], a[212:215], v[8:11], v[20:23]
v_mfma_f32_16x16x32_bf16 v[16:19], v[252:255], v[12:15], v[16:19]
v_mfma_f32_16x16x32_bf16 v[20:23], a[220:223], v[12:15], v[20:23]
s_nop 6
v_max3_f32 v42, v16, v17, v18
v_max3_f32 v43, v20, v21, v22
v_max3_f32 v42, v42, v19, v23
v_max3_f32 v42, v42, v43, v36
v_mov_b32 v43, v42
s_nop 1
v_permlane16_swap_b32 v42, v43
v_max_f32 v42, v42, v43
v_mov_b32 v43, v42
s_nop 1
v_permlane32_swap_b32 v42, v43
v_max_f32 v42, v42, v43
v_sub_f32 v43, v36, v42
v_exp_f32 v43, v43
v_mov_b32 v36, v42
v_sub_f32 v16, v16, v42
v_sub_f32 v17, v17, v42
v_sub_f32 v18, v18, v42
v_sub_f32 v19, v19, v42
v_sub_f32 v20, v20, v42
v_sub_f32 v21, v21, v42
v_sub_f32 v22, v22, v42
v_sub_f32 v23, v23, v42
v_exp_f32 v16, v16
v_exp_f32 v17, v17
v_exp_f32 v18, v18
v_exp_f32 v19, v19
v_exp_f32 v20, v20
v_exp_f32 v21, v21
v_exp_f32 v22, v22
v_exp_f32 v23, v23
v_mul_f32 v37, v37, v43
v_mul_f32 v32, v32, v43
v_mul_f32 v33, v33, v43
v_mul_f32 v34, v34, v43
v_mul_f32 v35, v35, v43
v_add_f32 v44, v16, v17
v_add_f32 v45, v18, v19
v_add_f32 v44, v44, v20
v_add_f32 v45, v45, v21
v_add_f32 v44, v44, v22
v_add_f32 v45, v45, v23
v_add_f32 v37, v37, v44
v_add_f32 v37, v37, v45
v_cvt_pk_bf16_f32 v16, v16, v17
v_cvt_pk_bf16_f32 v17, v18, v19
v_cvt_pk_bf16_f32 v18, v20, v21
v_cvt_pk_bf16_f32 v19, v22, v23
s_nop 1
Lsk_37:
s_waitcnt vmcnt(12)
ds_read_b64_tr_b16 a[194:195], v41 offset:12288
v_xor_b32 v46, 32, v41
ds_read_b64_tr_b16 a[202:203], v46 offset:12288
v_xor_b32 v47, 64, v41
ds_read_b64_tr_b16 a[210:211], v47 offset:12288
v_xor_b32 v46, 96, v41
ds_read_b64_tr_b16 a[218:219], v46 offset:12288
v_xor_b32 v47, 128, v41
ds_read_b64_tr_b16 a[226:227], v47 offset:12288
v_xor_b32 v46, 160, v41
ds_read_b64_tr_b16 a[234:235], v46 offset:12288
v_xor_b32 v47, 192, v41
ds_read_b64_tr_b16 a[242:243], v47 offset:12288
v_xor_b32 v46, 224, v41
ds_read_b64_tr_b16 a[250:251], v46 offset:12288
s_waitcnt lgkmcnt(0)
s_add_u32 m0, s90, 12288
s_nop 0
buffer_load_dwordx4 v38, s[8:11], s41 offen offset:0 nt lds
buffer_load_dwordx4 v39, s[8:11], s41 offen offset:1024 nt lds
buffer_load_dwordx4 v38, s[8:11], s41 offen offset:2048 nt lds
buffer_load_dwordx4 v39, s[8:11], s41 offen offset:3072 nt lds
s_cmp_eq_u32 s83, 0
s_cbranch_scc1 Lsk_38
v_mbcnt_lo_u32_b32 v46, -1, 0
v_mbcnt_hi_u32_b32 v46, -1, v46
v_and_b32 v47, 1, v46
v_lshlrev_b32 v47, 4, v47
v_lshrrev_b32 v46, 4, v46
v_lshl_add_u32 v46, v46, 5, v47
s_lshl_b32 s94, s80, 8
s_add_u32 s94, s94, 393216
buffer_load_dwordx4 v[0:3], v46, s[4:7], s94 offen offset:0 sc1
buffer_load_dwordx4 v[4:7], v46, s[4:7], s94 offen offset:128 sc1
Lsk_38:
s_sub_u32 s34, s34, 67108864
s_sub_u32 s35, s35, 67108864
s_sub_u32 s36, s36, 67108864
s_sub_u32 s37, s37, 67108864
s_sub_u32 s38, s38, 67108864
s_sub_u32 s39, s39, 67108864
s_sub_u32 s40, s40, 67108864
s_sub_u32 s41, s41, 67108864
s_sub_u32 s42, s42, 67108864
s_cmp_eq_u32 s85, 0
s_cbranch_scc1 Lsk_39
v_cndmask_b32_e64 v24, 0, v16, s[16:17]
v_cndmask_b32_e64 v25, 0, v17, s[16:17]
v_cndmask_b32_e64 v26, 0, v18, s[16:17]
v_cndmask_b32_e64 v27, 0, v19, s[16:17]
v_cndmask_b32_e64 v28, 0, v16, s[18:19]
v_cndmask_b32_e64 v29, 0, v17, s[18:19]
v_cndmask_b32_e64 v30, 0, v18, s[18:19]
v_cndmask_b32_e64 v31, 0, v19, s[18:19]
v_mfma_f32_16x16x32_bf16 v[32:35], a[192:195], v[24:27], v[32:35]
v_cndmask_b32_e64 v24, 0, v16, s[20:21]
v_cndmask_b32_e64 v25, 0, v17, s[20:21]
v_cndmask_b32_e64 v26, 0, v18, s[20:21]
v_cndmask_b32_e64 v27, 0, v19, s[20:21]
v_mfma_f32_16x16x32_bf16 v[32:35], a[200:203], v[28:31], v[32:35]
v_cndmask_b32_e64 v28, 0, v16, s[22:23]
v_cndmask_b32_e64 v29, 0, v17, s[22:23]
v_cndmask_b32_e64 v30, 0, v18, s[22:23]
v_cndmask_b32_e64 v31, 0, v19, s[22:23]
v_mfma_f32_16x16x32_bf16 v[32:35], a[208:211], v[24:27], v[32:35]
v_cndmask_b32_e64 v24, 0, v16, s[24:25]
v_cndmask_b32_e64 v25, 0, v17, s[24:25]
v_cndmask_b32_e64 v26, 0, v18, s[24:25]
v_cndmask_b32_e64 v27, 0, v19, s[24:25]
v_mfma_f32_16x16x32_bf16 v[32:35], a[216:219], v[28:31], v[32:35]
v_cndmask_b32_e64 v28, 0, v16, s[26:27]
v_cndmask_b32_e64 v29, 0, v17, s[26:27]
v_cndmask_b32_e64 v30, 0, v18, s[26:27]
v_cndmask_b32_e64 v31, 0, v19, s[26:27]
v_mfma_f32_16x16x32_bf16 v[32:35], a[224:227], v[24:27], v[32:35]
v_cndmask_b32_e64 v24, 0, v16, s[28:29]
v_cndmask_b32_e64 v25, 0, v17, s[28:29]
v_cndmask_b32_e64 v26, 0, v18, s[28:29]
v_cndmask_b32_e64 v27, 0, v19, s[28:29]
v_mfma_f32_16x16x32_bf16 v[32:35], a[232:235], v[28:31], v[32:35]
v_cndmask_b32_e64 v28, 0, v16, s[30:31]
v_cndmask_b32_e64 v29, 0, v17, s[30:31]
v_cndmask_b32_e64 v30, 0, v18, s[30:31]
v_cndmask_b32_e64 v31, 0, v19, s[30:31]
v_mfma_f32_16x16x32_bf16 v[32:35], a[240:243], v[24:27], v[32:35]
s_nop 0
v_mfma_f32_16x16x32_bf16 v[32:35], a[248:251], v[28:31], v[32:35]
s_waitcnt vmcnt(12)
ds_read_b128 a[228:231], v40 offset:16384
v_xor_b32 v46, 64, v40
ds_read_b128 a[236:239], v46 offset:16384
v_xor_b32 v47, 128, v40
ds_read_b128 a[244:247], v47 offset:16384
v_xor_b32 v46, 192, v40
ds_read_b128 a[252:255], v46 offset:16384
s_waitcnt vmcnt(0)
ds_read_b128 a[196:199], v40 offset:12288
v_xor_b32 v46, 64, v40
ds_read_b128 a[204:207], v46 offset:12288
v_xor_b32 v47, 128, v40
ds_read_b128 a[212:215], v47 offset:12288
v_xor_b32 v46, 192, v40
ds_read_b128 a[220:223], v46 offset:12288
s_waitcnt lgkmcnt(0)
v_mfma_f32_16x16x32_bf16 v[16:19], a[196:199], v[0:3], 0
v_mfma_f32_16x16x32_bf16 v[20:23], a[228:231], v[0:3], 0
v_mfma_f32_16x16x32_bf16 v[16:19], a[204:207], v[4:7], v[16:19]
v_mfma_f32_16x16x32_bf16 v[20:23], a[236:239], v[4:7], v[20:23]
v_mfma_f32_16x16x32_bf16 v[16:19], a[212:215], v[8:11], v[16:19]
v_mfma_f32_16x16x32_bf16 v[20:23], a[244:247], v[8:11], v[20:23]
v_mfma_f32_16x16x32_bf16 v[16:19], a[220:223], v[12:15], v[16:19]
v_mfma_f32_16x16x32_bf16 v[20:23], a[252:255], v[12:15], v[20:23]
s_nop 7
Lsk_39:
s_cmp_eq_u32 s83, 0
s_cbranch_scc1 Ldq_40
s_waitcnt vmcnt(6)
Ldq_40:
ds_read_b64_tr_b16 a[196:197], v41 offset:0
ds_read_b64_tr_b16 a[198:199], v41 offset:4096
v_xor_b32 v46, 32, v41
ds_read_b64_tr_b16 a[204:205], v46 offset:0
ds_read_b64_tr_b16 a[206:207], v46 offset:4096
v_xor_b32 v47, 64, v41
ds_read_b64_tr_b16 a[212:213], v47 offset:0
ds_read_b64_tr_b16 a[214:215], v47 offset:4096
v_xor_b32 v46, 96, v41
ds_read_b64_tr_b16 a[220:221], v46 offset:0
ds_read_b64_tr_b16 a[222:223], v46 offset:4096
v_xor_b32 v47, 128, v41
ds_read_b64_tr_b16 a[228:229], v47 offset:0
ds_read_b64_tr_b16 a[230:231], v47 offset:4096
v_xor_b32 v46, 160, v41
ds_read_b64_tr_b16 a[236:237], v46 offset:0
ds_read_b64_tr_b16 a[238:239], v46 offset:4096
v_xor_b32 v47, 192, v41
ds_read_b64_tr_b16 a[244:245], v47 offset:0
ds_read_b64_tr_b16 a[246:247], v47 offset:4096
v_xor_b32 v46, 224, v41
ds_read_b64_tr_b16 a[252:253], v46 offset:0
ds_read_b64_tr_b16 a[254:255], v46 offset:4096
s_cmp_eq_u32 s85, 0
s_cbranch_scc1 Lsk_41
s_waitcnt lgkmcnt(0)
v_max3_f32 v42, v16, v17, v18
v_max3_f32 v43, v20, v21, v22
v_max3_f32 v42, v42, v19, v23
v_max3_f32 v42, v42, v43, v36
v_mov_b32 v43, v42
s_nop 1
v_permlane16_swap_b32 v42, v43
v_max_f32 v42, v42, v43
v_mov_b32 v43, v42
s_nop 1
v_permlane32_swap_b32 v42, v43
v_max_f32 v42, v42, v43
v_sub_f32 v43, v36, v42
v_exp_f32 v43, v43
v_mov_b32 v36, v42
v_sub_f32 v16, v16, v42
v_sub_f32 v17, v17, v42
v_sub_f32 v18, v18, v42
v_sub_f32 v19, v19, v42
v_sub_f32 v20, v20, v42
v_sub_f32 v21, v21, v42
v_sub_f32 v22, v22, v42
v_sub_f32 v23, v23, v42
v_exp_f32 v16, v16
v_exp_f32 v17, v17
v_exp_f32 v18, v18
v_exp_f32 v19, v19
v_exp_f32 v20, v20
v_exp_f32 v21, v21
v_exp_f32 v22, v22
v_exp_f32 v23, v23
v_mul_f32 v37, v37, v43
v_mul_f32 v32, v32, v43
v_mul_f32 v33, v33, v43
v_mul_f32 v34, v34, v43
v_mul_f32 v35, v35, v43
v_add_f32 v44, v16, v17
v_add_f32 v45, v18, v19
v_add_f32 v44, v44, v20
v_add_f32 v45, v45, v21
v_add_f32 v44, v44, v22
v_add_f32 v45, v45, v23
v_add_f32 v37, v37, v44
v_add_f32 v37, v37, v45
v_cvt_pk_bf16_f32 v16, v16, v17
v_cvt_pk_bf16_f32 v17, v18, v19
v_cvt_pk_bf16_f32 v18, v20, v21
v_cvt_pk_bf16_f32 v19, v22, v23
v_cndmask_b32_e64 v24, 0, v16, s[16:17]
v_cndmask_b32_e64 v25, 0, v17, s[16:17]
v_cndmask_b32_e64 v26, 0, v18, s[16:17]
v_cndmask_b32_e64 v27, 0, v19, s[16:17]
v_cndmask_b32_e64 v28, 0, v16, s[18:19]
v_cndmask_b32_e64 v29, 0, v17, s[18:19]
v_cndmask_b32_e64 v30, 0, v18, s[18:19]
v_cndmask_b32_e64 v31, 0, v19, s[18:19]
v_mfma_f32_16x16x32_bf16 v[32:35], a[196:199], v[24:27], v[32:35]
v_cndmask_b32_e64 v24, 0, v16, s[20:21]
v_cndmask_b32_e64 v25, 0, v17, s[20:21]
v_cndmask_b32_e64 v26, 0, v18, s[20:21]
v_cndmask_b32_e64 v27, 0, v19, s[20:21]
v_mfma_f32_16x16x32_bf16 v[32:35], a[204:207], v[28:31], v[32:35]
v_cndmask_b32_e64 v28, 0, v16, s[22:23]
v_cndmask_b32_e64 v29, 0, v17, s[22:23]
v_cndmask_b32_e64 v30, 0, v18, s[22:23]
v_cndmask_b32_e64 v31, 0, v19, s[22:23]
v_mfma_f32_16x16x32_bf16 v[32:35], a[212:215], v[24:27], v[32:35]
v_cndmask_b32_e64 v24, 0, v16, s[24:25]
v_cndmask_b32_e64 v25, 0, v17, s[24:25]
v_cndmask_b32_e64 v26, 0, v18, s[24:25]
v_cndmask_b32_e64 v27, 0, v19, s[24:25]
v_mfma_f32_16x16x32_bf16 v[32:35], a[220:223], v[28:31], v[32:35]
v_cndmask_b32_e64 v28, 0, v16, s[26:27]
v_cndmask_b32_e64 v29, 0, v17, s[26:27]
v_cndmask_b32_e64 v30, 0, v18, s[26:27]
v_cndmask_b32_e64 v31, 0, v19, s[26:27]
v_mfma_f32_16x16x32_bf16 v[32:35], a[228:231], v[24:27], v[32:35]
v_cndmask_b32_e64 v24, 0, v16, s[28:29]
v_cndmask_b32_e64 v25, 0, v17, s[28:29]
v_cndmask_b32_e64 v26, 0, v18, s[28:29]
v_cndmask_b32_e64 v27, 0, v19, s[28:29]
v_mfma_f32_16x16x32_bf16 v[32:35], a[236:239], v[28:31], v[32:35]
v_cndmask_b32_e64 v28, 0, v16, s[30:31]
v_cndmask_b32_e64 v29, 0, v17, s[30:31]
v_cndmask_b32_e64 v30, 0, v18, s[30:31]
v_cndmask_b32_e64 v31, 0, v19, s[30:31]
v_mfma_f32_16x16x32_bf16 v[32:35], a[244:247], v[24:27], v[32:35]
s_nop 0
v_mfma_f32_16x16x32_bf16 v[32:35], a[252:255], v[28:31], v[32:35]
s_mov_b32 s92, 1
s_mov_b32 s87, 0
s_nop 5
s_branch L_pub1
L_retB:
v_mov_b32 v36, 0xff800000
v_mov_b32 v37, 0
v_mov_b32 v32, 0
v_mov_b32 v33, 0
v_mov_b32 v34, 0
v_mov_b32 v35, 0
s_lshl_b32 s88, s83, 2
s_add_u32 s88, s88, 148520
v_mov_b32 v46, s88
v_mov_b32 v47, 1
s_mov_b32 exec_lo, 0x1
s_mov_b32 exec_hi, 0x0
ds_add_rtn_u32 v42, v46, v47
s_waitcnt lgkmcnt(0)
v_readfirstlane_b32 s88, v42
s_mov_b64 exec, -1
s_cmp_lg_u32 s88, 0
s_nop 2
s_cbranch_scc1 Lhww_42
v_mbcnt_lo_u32_b32 v46, -1, 0
v_mbcnt_hi_u32_b32 v46, -1, v46
v_mul_u32_u24 v46, 640, v46
s_mul_i32 s89, s80, 5120
s_mul_i32 s91, s92, 196608
s_add_u32 s89, s89, s91
s_add_u32 s89, s89, 8704
s_mov_b32 exec_lo, 0x7f
s_mov_b32 exec_hi, 0x0
Lhw_43:
buffer_load_dword v47, v46, s[4:7], s89 offen sc1
s_waitcnt vmcnt(0)
v_cmp_ne_u32 vcc, -1, v47
s_bcnt1_i32_b64 s91, vcc
s_cmp_ge_u32 s91, 1
s_cbranch_scc1 Lhwd_44
s_sub_u32 s81, s81, 1
s_cbranch_scc0 Lhw_43
s_mov_b32 s81, 0
Lhwd_44:
s_mov_b64 exec, -1
s_lshl_b32 s88, s83, 2
s_add_u32 s88, s88, 148528
v_mov_b32 v46, s88
v_mov_b32 v47, 1
ds_write_b32 v46, v47
s_nop 0
Lhww_42:
s_lshl_b32 s88, s83, 2
s_add_u32 s88, s88, 148528
v_mov_b32 v46, s88
s_nop 1
Lfw_45:
ds_read_b32 v47, v46
s_waitcnt lgkmcnt(0)
v_cmp_eq_u32 vcc, 0, v47
s_nop 1
s_cbranch_vccz Lfwd_46
s_sub_u32 s95, s95, 1
s_cbranch_scc0 Lfw_45
s_mov_b32 s95, 0
Lfwd_46:
s_mov_b32 m0, s90
s_nop 0
buffer_load_dwordx4 v38, s[8:11], s40 offen offset:0 nt lds
buffer_load_dwordx4 v39, s[8:11], s40 offen offset:1024 nt lds
buffer_load_dwordx4 v38, s[8:11], s40 offen offset:2048 nt lds
buffer_load_dwordx4 v39, s[8:11], s40 offen offset:3072 nt lds
s_add_u32 s88, s40, 4096
s_add_u32 m0, s90, 4096
s_nop 0
buffer_load_dwordx4 v38, s[8:11], s88 offen offset:0 nt lds
buffer_load_dwordx4 v39, s[8:11], s88 offen offset:1024 nt lds
buffer_load_dwordx4 v38, s[8:11], s88 offen offset:2048 nt lds
buffer_load_dwordx4 v39, s[8:11], s88 offen offset:3072 nt lds
v_mbcnt_lo_u32_b32 v45, -1, 0
v_mbcnt_hi_u32_b32 v45, -1, v45
v_lshrrev_b32 v45, 4, v45
v_lshlrev_b32 v45, 4, v45
v_add_u32 v45, 147456, v45
s_waitcnt vmcnt(4)
ds_read_b128 v[0:3], v40 offset:0
v_xor_b32 v46, 64, v40
ds_read_b128 v[4:7], v46 offset:0
v_xor_b32 v47, 128, v40
ds_read_b128 v[8:11], v47 offset:0
v_xor_b32 v46, 192, v40
ds_read_b128 v[12:15], v46 offset:0
ds_read_b128 v[24:27], v45 offset:0
ds_read_b128 v[28:31], v45 offset:64
s_waitcnt lgkmcnt(2)
s_mov_b32 m0, s90
s_nop 0
buffer_load_dwordx4 v38, s[12:15], s40 offen offset:0  lds
buffer_load_dwordx4 v39, s[12:15], s40 offen offset:1024  lds
buffer_load_dwordx4 v38, s[12:15], s40 offen offset:2048  lds
buffer_load_dwordx4 v39, s[12:15], s40 offen offset:3072  lds
s_waitcnt lgkmcnt(1)
v_mfma_f32_16x16x32_bf16 v[16:19], v[0:3], v[24:27], 0
ds_read_b128 v[24:27], v45 offset:128
s_waitcnt lgkmcnt(1)
v_mfma_f32_16x16x32_bf16 v[16:19], v[4:7], v[28:31], v[16:19]
ds_read_b128 v[28:31], v45 offset:192
s_waitcnt lgkmcnt(1)
v_mfma_f32_16x16x32_bf16 v[16:19], v[8:11], v[24:27], v[16:19]
s_waitcnt lgkmcnt(0)
v_mfma_f32_16x16x32_bf16 v[16:19], v[12:15], v[28:31], v[16:19]
s_waitcnt vmcnt(4)
ds_read_b128 v[0:3], v40 offset:4096
v_xor_b32 v46, 64, v40
ds_read_b128 v[4:7], v46 offset:4096
v_xor_b32 v47, 128, v40
ds_read_b128 v[8:11], v47 offset:4096
v_xor_b32 v46, 192, v40
ds_read_b128 v[12:15], v46 offset:4096
ds_read_b128 v[24:27], v45 offset:0
ds_read_b128 v[28:31], v45 offset:64
s_waitcnt lgkmcnt(2)
s_add_u32 s88, s40, 4096
s_add_u32 m0, s90, 4096
s_nop 0
buffer_load_dwordx4 v38, s[12:15], s88 offen offset:0  lds
buffer_load_dwordx4 v39, s[12:15], s88 offen offset:1024  lds
buffer_load_dwordx4 v38, s[12:15], s88 offen offset:2048  lds
buffer_load_dwordx4 v39, s[12:15], s88 offen offset:3072  lds
s_waitcnt lgkmcnt(1)
v_mfma_f32_16x16x32_bf16 v[20:23], v[0:3], v[24:27], 0
ds_read_b128 v[24:27], v45 offset:128
s_waitcnt lgkmcnt(1)
v_mfma_f32_16x16x32_bf16 v[20:23], v[4:7], v[28:31], v[20:23]
ds_read_b128 v[28:31], v45 offset:192
s_waitcnt lgkmcnt(1)
v_mfma_f32_16x16x32_bf16 v[20:23], v[8:11], v[24:27], v[20:23]
s_waitcnt lgkmcnt(0)
v_mfma_f32_16x16x32_bf16 v[20:23], v[12:15], v[28:31], v[20:23]
v_max3_f32 v42, v16, v17, v18
s_nop 6
v_max3_f32 v43, v20, v21, v22
v_max3_f32 v42, v42, v19, v23
v_max3_f32 v42, v42, v43, v36
v_mov_b32 v43, v42
s_nop 1
v_permlane16_swap_b32 v42, v43
v_max_f32 v42, v42, v43
v_mov_b32 v43, v42
s_nop 1
v_permlane32_swap_b32 v42, v43
v_max_f32 v42, v42, v43
v_sub_f32 v43, v36, v42
v_exp_f32 v43, v43
v_mov_b32 v36, v42
v_sub_f32 v16, v16, v42
v_sub_f32 v17, v17, v42
v_sub_f32 v18, v18, v42
v_sub_f32 v19, v19, v42
v_sub_f32 v20, v20, v42
v_sub_f32 v21, v21, v42
v_sub_f32 v22, v22, v42
v_sub_f32 v23, v23, v42
v_exp_f32 v16, v16
v_exp_f32 v17, v17
v_exp_f32 v18, v18
v_exp_f32 v19, v19
v_exp_f32 v20, v20
v_exp_f32 v21, v21
v_exp_f32 v22, v22
v_exp_f32 v23, v23
v_mul_f32 v37, v37, v43
v_mul_f32 v32, v32, v43
v_mul_f32 v33, v33, v43
v_mul_f32 v34, v34, v43
v_mul_f32 v35, v35, v43
v_add_f32 v44, v16, v17
v_add_f32 v45, v18, v19
v_add_f32 v44, v44, v20
v_add_f32 v45, v45, v21
v_add_f32 v44, v44, v22
v_add_f32 v45, v45, v23
v_add_f32 v37, v37, v44
v_add_f32 v37, v37, v45
v_cvt_pk_bf16_f32 v16, v16, v17
v_cvt_pk_bf16_f32 v17, v18, v19
v_cvt_pk_bf16_f32 v18, v20, v21
v_cvt_pk_bf16_f32 v19, v22, v23
s_waitcnt vmcnt(0)
ds_read_b64_tr_b16 v[0:1], v41 offset:0
ds_read_b64_tr_b16 v[2:3], v41 offset:4096
v_xor_b32 v46, 32, v41
ds_read_b64_tr_b16 v[4:5], v46 offset:0
ds_read_b64_tr_b16 v[6:7], v46 offset:4096
v_xor_b32 v47, 64, v41
ds_read_b64_tr_b16 v[8:9], v47 offset:0
ds_read_b64_tr_b16 v[10:11], v47 offset:4096
v_xor_b32 v46, 96, v41
ds_read_b64_tr_b16 v[12:13], v46 offset:0
ds_read_b64_tr_b16 v[14:15], v46 offset:4096
s_waitcnt lgkmcnt(0)
v_cndmask_b32_e64 v24, 0, v16, s[16:17]
v_cndmask_b32_e64 v25, 0, v17, s[16:17]
v_cndmask_b32_e64 v26, 0, v18, s[16:17]
v_cndmask_b32_e64 v27, 0, v19, s[16:17]
v_cndmask_b32_e64 v28, 0, v16, s[18:19]
v_cndmask_b32_e64 v29, 0, v17, s[18:19]
v_cndmask_b32_e64 v30, 0, v18, s[18:19]
v_cndmask_b32_e64 v31, 0, v19, s[18:19]
v_mfma_f32_16x16x32_bf16 v[32:35], v[0:3], v[24:27], v[32:35]
v_cndmask_b32_e64 v24, 0, v16, s[20:21]
v_cndmask_b32_e64 v25, 0, v17, s[20:21]
v_cndmask_b32_e64 v26, 0, v18, s[20:21]
v_cndmask_b32_e64 v27, 0, v19, s[20:21]
v_mfma_f32_16x16x32_bf16 v[32:35], v[4:7], v[28:31], v[32:35]
v_cndmask_b32_e64 v28, 0, v16, s[22:23]
v_cndmask_b32_e64 v29, 0, v17, s[22:23]
v_cndmask_b32_e64 v30, 0, v18, s[22:23]
v_cndmask_b32_e64 v31, 0, v19, s[22:23]
v_mfma_f32_16x16x32_bf16 v[32:35], v[8:11], v[24:27], v[32:35]
s_nop 0
v_mfma_f32_16x16x32_bf16 v[32:35], v[12:15], v[28:31], v[32:35]
v_xor_b32 v47, 128, v41
ds_read_b64_tr_b16 v[0:1], v47 offset:0
ds_read_b64_tr_b16 v[2:3], v47 offset:4096
v_xor_b32 v46, 160, v41
ds_read_b64_tr_b16 v[4:5], v46 offset:0
ds_read_b64_tr_b16 v[6:7], v46 offset:4096
v_xor_b32 v47, 192, v41
ds_read_b64_tr_b16 v[8:9], v47 offset:0
ds_read_b64_tr_b16 v[10:11], v47 offset:4096
v_xor_b32 v46, 224, v41
ds_read_b64_tr_b16 v[12:13], v46 offset:0
ds_read_b64_tr_b16 v[14:15], v46 offset:4096
s_waitcnt lgkmcnt(0)
s_mov_b32 m0, s90
s_nop 0
buffer_load_dwordx4 v38, s[8:11], s41 offen offset:0  lds
buffer_load_dwordx4 v39, s[8:11], s41 offen offset:1024  lds
buffer_load_dwordx4 v38, s[8:11], s41 offen offset:2048  lds
buffer_load_dwordx4 v39, s[8:11], s41 offen offset:3072  lds
s_add_u32 s88, s41, 4096
s_add_u32 m0, s90, 4096
s_nop 0
buffer_load_dwordx4 v38, s[8:11], s88 offen offset:0  lds
buffer_load_dwordx4 v39, s[8:11], s88 offen offset:1024  lds
buffer_load_dwordx4 v38, s[8:11], s88 offen offset:2048  lds
buffer_load_dwordx4 v39, s[8:11], s88 offen offset:3072  lds
v_cndmask_b32_e64 v24, 0, v16, s[24:25]
v_cndmask_b32_e64 v25, 0, v17, s[24:25]
v_cndmask_b32_e64 v26, 0, v18, s[24:25]
v_cndmask_b32_e64 v27, 0, v19, s[24:25]
v_cndmask_b32_e64 v28, 0, v16, s[26:27]
v_cndmask_b32_e64 v29, 0, v17, s[26:27]
v_cndmask_b32_e64 v30, 0, v18, s[26:27]
v_cndmask_b32_e64 v31, 0, v19, s[26:27]
v_mfma_f32_16x16x32_bf16 v[32:35], v[0:3], v[24:27], v[32:35]
v_cndmask_b32_e64 v24, 0, v16, s[28:29]
v_cndmask_b32_e64 v25, 0, v17, s[28:29]
v_cndmask_b32_e64 v26, 0, v18, s[28:29]
v_cndmask_b32_e64 v27, 0, v19, s[28:29]
v_mfma_f32_16x16x32_bf16 v[32:35], v[4:7], v[28:31], v[32:35]
v_cndmask_b32_e64 v28, 0, v16, s[30:31]
v_cndmask_b32_e64 v29, 0, v17, s[30:31]
v_cndmask_b32_e64 v30, 0, v18, s[30:31]
v_cndmask_b32_e64 v31, 0, v19, s[30:31]
v_mfma_f32_16x16x32_bf16 v[32:35], v[8:11], v[24:27], v[32:35]
s_nop 0
v_mfma_f32_16x16x32_bf16 v[32:35], v[12:15], v[28:31], v[32:35]
v_mbcnt_lo_u32_b32 v45, -1, 0
v_mbcnt_hi_u32_b32 v45, -1, v45
v_lshrrev_b32 v45, 4, v45
v_lshlrev_b32 v45, 4, v45
v_add_u32 v45, 147456, v45
s_waitcnt vmcnt(4)
ds_read_b128 v[0:3], v40 offset:0
v_xor_b32 v46, 64, v40
ds_read_b128 v[4:7], v46 offset:0
v_xor_b32 v47, 128, v40
ds_read_b128 v[8:11], v47 offset:0
v_xor_b32 v46, 192, v40
ds_read_b128 v[12:15], v46 offset:0
ds_read_b128 v[24:27], v45 offset:0
ds_read_b128 v[28:31], v45 offset:64
s_waitcnt lgkmcnt(2)
s_mov_b32 m0, s90
s_nop 0
buffer_load_dwordx4 v38, s[12:15], s41 offen offset:0  lds
buffer_load_dwordx4 v39, s[12:15], s41 offen offset:1024  lds
buffer_load_dwordx4 v38, s[12:15], s41 offen offset:2048  lds
buffer_load_dwordx4 v39, s[12:15], s41 offen offset:3072  lds
s_waitcnt lgkmcnt(1)
v_mfma_f32_16x16x32_bf16 v[16:19], v[0:3], v[24:27], 0
ds_read_b128 v[24:27], v45 offset:128
s_waitcnt lgkmcnt(1)
v_mfma_f32_16x16x32_bf16 v[16:19], v[4:7], v[28:31], v[16:19]
ds_read_b128 v[28:31], v45 offset:192
s_waitcnt lgkmcnt(1)
v_mfma_f32_16x16x32_bf16 v[16:19], v[8:11], v[24:27], v[16:19]
s_waitcnt lgkmcnt(0)
v_mfma_f32_16x16x32_bf16 v[16:19], v[12:15], v[28:31], v[16:19]
s_waitcnt vmcnt(4)
ds_read_b128 v[0:3], v40 offset:4096
v_xor_b32 v46, 64, v40
ds_read_b128 v[4:7], v46 offset:4096
v_xor_b32 v47, 128, v40
ds_read_b128 v[8:11], v47 offset:4096
v_xor_b32 v46, 192, v40
ds_read_b128 v[12:15], v46 offset:4096
ds_read_b128 v[24:27], v45 offset:0
ds_read_b128 v[28:31], v45 offset:64
s_waitcnt lgkmcnt(2)
s_add_u32 s88, s41, 4096
s_add_u32 m0, s90, 4096
s_nop 0
buffer_load_dwordx4 v38, s[12:15], s88 offen offset:0  lds
buffer_load_dwordx4 v39, s[12:15], s88 offen offset:1024  lds
buffer_load_dwordx4 v38, s[12:15], s88 offen offset:2048  lds
buffer_load_dwordx4 v39, s[12:15], s88 offen offset:3072  lds
v_mbcnt_lo_u32_b32 v46, -1, 0
v_mbcnt_hi_u32_b32 v46, -1, v46
v_lshlrev_b32 v46, 2, v46
s_lshl_b32 s94, s80, 8
s_add_u32 s94, s94, 589824
s_lshl_b32 s88, s3, 8
s_add_u32 m0, s88, 162304
s_nop 0
buffer_load_dword v46, s[4:7], s94 offen sc1 lds
s_waitcnt lgkmcnt(1)
v_mfma_f32_16x16x32_bf16 v[20:23], v[0:3], v[24:27], 0
ds_read_b128 v[24:27], v45 offset:128
s_waitcnt lgkmcnt(1)
v_mfma_f32_16x16x32_bf16 v[20:23], v[4:7], v[28:31], v[20:23]
ds_read_b128 v[28:31], v45 offset:192
s_waitcnt lgkmcnt(1)
v_mfma_f32_16x16x32_bf16 v[20:23], v[8:11], v[24:27], v[20:23]
s_waitcnt lgkmcnt(0)
v_mfma_f32_16x16x32_bf16 v[20:23], v[12:15], v[28:31], v[20:23]
v_max3_f32 v42, v16, v17, v18
s_nop 6
v_max3_f32 v43, v20, v21, v22
v_max3_f32 v42, v42, v19, v23
v_max3_f32 v42, v42, v43, v36
v_mov_b32 v43, v42
s_nop 1
v_permlane16_swap_b32 v42, v43
v_max_f32 v42, v42, v43
v_mov_b32 v43, v42
s_nop 1
v_permlane32_swap_b32 v42, v43
v_max_f32 v42, v42, v43
v_sub_f32 v43, v36, v42
v_exp_f32 v43, v43
v_mov_b32 v36, v42
v_sub_f32 v16, v16, v42
v_sub_f32 v17, v17, v42
v_sub_f32 v18, v18, v42
v_sub_f32 v19, v19, v42
v_sub_f32 v20, v20, v42
v_sub_f32 v21, v21, v42
v_sub_f32 v22, v22, v42
v_sub_f32 v23, v23, v42
v_exp_f32 v16, v16
v_exp_f32 v17, v17
v_exp_f32 v18, v18
v_exp_f32 v19, v19
v_exp_f32 v20, v20
v_exp_f32 v21, v21
v_exp_f32 v22, v22
v_exp_f32 v23, v23
v_mul_f32 v37, v37, v43
v_mul_f32 v32, v32, v43
v_mul_f32 v33, v33, v43
v_mul_f32 v34, v34, v43
v_mul_f32 v35, v35, v43
v_add_f32 v44, v16, v17
v_add_f32 v45, v18, v19
v_add_f32 v44, v44, v20
v_add_f32 v45, v45, v21
v_add_f32 v44, v44, v22
v_add_f32 v45, v45, v23
v_add_f32 v37, v37, v44
v_add_f32 v37, v37, v45
v_cvt_pk_bf16_f32 v16, v16, v17
v_cvt_pk_bf16_f32 v17, v18, v19
v_cvt_pk_bf16_f32 v18, v20, v21
v_cvt_pk_bf16_f32 v19, v22, v23
s_waitcnt vmcnt(1)
ds_read_b64_tr_b16 v[0:1], v41 offset:0
ds_read_b64_tr_b16 v[2:3], v41 offset:4096
v_xor_b32 v46, 32, v41
ds_read_b64_tr_b16 v[4:5], v46 offset:0
ds_read_b64_tr_b16 v[6:7], v46 offset:4096
v_xor_b32 v47, 64, v41
ds_read_b64_tr_b16 v[8:9], v47 offset:0
ds_read_b64_tr_b16 v[10:11], v47 offset:4096
v_xor_b32 v46, 96, v41
ds_read_b64_tr_b16 v[12:13], v46 offset:0
ds_read_b64_tr_b16 v[14:15], v46 offset:4096
s_waitcnt lgkmcnt(0)
v_cndmask_b32_e64 v24, 0, v16, s[16:17]
v_cndmask_b32_e64 v25, 0, v17, s[16:17]
v_cndmask_b32_e64 v26, 0, v18, s[16:17]
v_cndmask_b32_e64 v27, 0, v19, s[16:17]
v_cndmask_b32_e64 v28, 0, v16, s[18:19]
v_cndmask_b32_e64 v29, 0, v17, s[18:19]
v_cndmask_b32_e64 v30, 0, v18, s[18:19]
v_cndmask_b32_e64 v31, 0, v19, s[18:19]
v_mfma_f32_16x16x32_bf16 v[32:35], v[0:3], v[24:27], v[32:35]
v_cndmask_b32_e64 v24, 0, v16, s[20:21]
v_cndmask_b32_e64 v25, 0, v17, s[20:21]
v_cndmask_b32_e64 v26, 0, v18, s[20:21]
v_cndmask_b32_e64 v27, 0, v19, s[20:21]
v_mfma_f32_16x16x32_bf16 v[32:35], v[4:7], v[28:31], v[32:35]
v_cndmask_b32_e64 v28, 0, v16, s[22:23]
v_cndmask_b32_e64 v29, 0, v17, s[22:23]
v_cndmask_b32_e64 v30, 0, v18, s[22:23]
v_cndmask_b32_e64 v31, 0, v19, s[22:23]
v_mfma_f32_16x16x32_bf16 v[32:35], v[8:11], v[24:27], v[32:35]
s_nop 0
v_mfma_f32_16x16x32_bf16 v[32:35], v[12:15], v[28:31], v[32:35]
v_xor_b32 v47, 128, v41
ds_read_b64_tr_b16 v[0:1], v47 offset:0
ds_read_b64_tr_b16 v[2:3], v47 offset:4096
v_xor_b32 v46, 160, v41
ds_read_b64_tr_b16 v[4:5], v46 offset:0
ds_read_b64_tr_b16 v[6:7], v46 offset:4096
v_xor_b32 v47, 192, v41
ds_read_b64_tr_b16 v[8:9], v47 offset:0
ds_read_b64_tr_b16 v[10:11], v47 offset:4096
v_xor_b32 v46, 224, v41
ds_read_b64_tr_b16 v[12:13], v46 offset:0
ds_read_b64_tr_b16 v[14:15], v46 offset:4096
s_waitcnt lgkmcnt(0)
v_cndmask_b32_e64 v24, 0, v16, s[24:25]
v_cndmask_b32_e64 v25, 0, v17, s[24:25]
v_cndmask_b32_e64 v26, 0, v18, s[24:25]
v_cndmask_b32_e64 v27, 0, v19, s[24:25]
v_cndmask_b32_e64 v28, 0, v16, s[26:27]
v_cndmask_b32_e64 v29, 0, v17, s[26:27]
v_cndmask_b32_e64 v30, 0, v18, s[26:27]
v_cndmask_b32_e64 v31, 0, v19, s[26:27]
v_mfma_f32_16x16x32_bf16 v[32:35], v[0:3], v[24:27], v[32:35]
v_cndmask_b32_e64 v24, 0, v16, s[28:29]
v_cndmask_b32_e64 v25, 0, v17, s[28:29]
v_cndmask_b32_e64 v26, 0, v18, s[28:29]
v_cndmask_b32_e64 v27, 0, v19, s[28:29]
v_mfma_f32_16x16x32_bf16 v[32:35], v[4:7], v[28:31], v[32:35]
v_cndmask_b32_e64 v28, 0, v16, s[30:31]
v_cndmask_b32_e64 v29, 0, v17, s[30:31]
v_cndmask_b32_e64 v30, 0, v18, s[30:31]
v_cndmask_b32_e64 v31, 0, v19, s[30:31]
v_mfma_f32_16x16x32_bf16 v[32:35], v[8:11], v[24:27], v[32:35]
s_nop 0
v_mfma_f32_16x16x32_bf16 v[32:35], v[12:15], v[28:31], v[32:35]
v_mbcnt_lo_u32_b32 v46, -1, 0
v_mbcnt_hi_u32_b32 v46, -1, v46
v_and_b32 v47, 1, v46
v_lshlrev_b32 v47, 4, v47
v_lshrrev_b32 v46, 4, v46
v_lshl_add_u32 v46, v46, 5, v47
s_lshl_b32 s88, s3, 8
s_add_u32 s88, s88, 162304
v_add_u32 v47, s88, v46
s_waitcnt vmcnt(0)
ds_read_b128 v[0:3], v47 offset:0
ds_read_b128 v[4:7], v47 offset:128
s_waitcnt lgkmcnt(0)
v_max3_u32 v42, v0, v1, v2
v_max_u32 v42, v42, v3
v_max3_u32 v43, v4, v5, v6
v_max_u32 v43, v43, v7
v_max_u32 v42, v42, v43
v_cmp_eq_u32 vcc, -1, v42
s_nop 1
s_cbranch_vccz Lq2s_47
buffer_load_dwordx4 v[0:3], v46, s[4:7], s94 offen offset:0 sc1
buffer_load_dwordx4 v[4:7], v46, s[4:7], s94 offen offset:128 sc1
Lq2s_47:
s_mov_b32 m0, s90
s_nop 0
buffer_load_dwordx4 v38, s[8:11], s34 offen offset:0 nt lds
buffer_load_dwordx4 v39, s[8:11], s34 offen offset:1024 nt lds
buffer_load_dwordx4 v38, s[8:11], s34 offen offset:2048 nt lds
buffer_load_dwordx4 v39, s[8:11], s34 offen offset:3072 nt lds
s_add_u32 s88, s34, 4096
s_add_u32 m0, s90, 4096
s_nop 0
buffer_load_dwordx4 v38, s[8:11], s88 offen offset:0 nt lds
buffer_load_dwordx4 v39, s[8:11], s88 offen offset:1024 nt lds
buffer_load_dwordx4 v38, s[8:11], s88 offen offset:2048 nt lds
buffer_load_dwordx4 v39, s[8:11], s88 offen offset:3072 nt lds
Lsk_41:
s_waitcnt lgkmcnt(0)
s_sub_u32 s92, 3, s83
v_mbcnt_lo_u32_b32 v46, -1, 0
v_mbcnt_hi_u32_b32 v46, -1, v46
v_and_b32 v47, 1, v46
v_mul_u32_u24 v8, 0xaaaa, v47
v_add_u32 v8, 0x4444, v8
v_lshlrev_b32 v15, 4, v47
v_lshrrev_b32 v45, 4, v46
v_lshl_add_u32 v15, v45, 5, v15
s_mul_i32 s88, s3, 640
s_add_u32 s88, s88, 159744
v_add_u32 v45, s88, v15
v_lshlrev_b32 v14, 1, v47
v_and_b32 v47, 2, v46
v_lshl_or_b32 v14, v47, 3, v14
v_and_b32 v47, 4, v46
v_lshl_or_b32 v14, v47, 1, v14
v_and_b32 v47, 8, v46
v_lshl_or_b32 v14, v47, 2, v14
v_bfe_u32 v47, v46, 4, 1
v_lshl_or_b32 v14, v47, 2, v14
v_and_b32 v47, 32, v46
v_lshl_or_b32 v14, v47, 1, v14
v_add_u32 v14, s88, v14
v_mov_b32 v13, 0xff800000
v_mov_b64 v[16:17], 0
v_mov_b64 v[20:21], 0
v_mov_b64 v[24:25], 0
v_mov_b64 v[28:29], 0
v_xor_b32 v44, 192, v40
s_cmp_eq_u32 s83, 0
s_nop 0
s_cbranch_scc1 Ldq_48
s_waitcnt vmcnt(0)
Ldq_48:
s_waitcnt vmcnt(8)
v_max3_u32 v42, v0, v1, v2
v_max_u32 v42, v42, v3
v_max3_u32 v43, v4, v5, v6
v_max_u32 v43, v43, v7
v_max_u32 v42, v42, v43
v_cmp_eq_u32 vcc, -1, v42
s_nop 1
s_cbranch_vccz Lq2d_49
Lq2p_50:
buffer_load_dwordx4 v[0:3], v15, s[4:7], s94 offen offset:0 sc1
buffer_load_dwordx4 v[4:7], v15, s[4:7], s94 offen offset:128 sc1
s_waitcnt vmcnt(0)
v_max3_u32 v42, v0, v1, v2
v_max_u32 v42, v42, v3
v_max3_u32 v43, v4, v5, v6
v_max_u32 v43, v43, v7
v_max_u32 v42, v42, v43
v_cmp_eq_u32 vcc, -1, v42
s_nop 1
s_cbranch_vccz Lq2d_49
s_sub_u32 s81, s81, 1
s_cbranch_scc0 Lq2p_50
s_mov_b32 s81, 0
Lq2d_49:
s_xor_b32 s87, s83, 1
v_xor_b32 v46, 64, v40
v_xor_b32 v47, 128, v40
v_smfmac_f32_16x16x64_bf16 v[16:19], v[0:3], v[48:55], v8
v_smfmac_f32_16x16x64_bf16 v[16:19], v[4:7], v[56:63], v8
ds_read_b128 v[48:51], v40 offset:8192
v_smfmac_f32_16x16x64_bf16 v[20:23], v[0:3], v[64:71], v8
ds_read_b128 v[52:55], v46 offset:8192
v_smfmac_f32_16x16x64_bf16 v[20:23], v[4:7], v[72:79], v8
ds_read_b128 v[56:59], v47 offset:8192
v_smfmac_f32_16x16x64_bf16 v[24:27], v[0:3], v[80:87], v8
ds_read_b128 v[60:63], v44 offset:8192
s_nop 0
v_add_f32_dpp v9, v16, v17 quad_perm:[0,1,2,3] row_mask:0x1 bank_mask:0xf
v_smfmac_f32_16x16x64_bf16 v[24:27], v[4:7], v[88:95], v8
ds_read_b128 v[64:67], v40 offset:12288
v_mov_b64 v[16:17], 0
v_smfmac_f32_16x16x64_bf16 v[28:31], v[0:3], v[96:103], v8
ds_read_b128 v[68:71], v46 offset:12288
v_add_f32_dpp v9, v20, v21 quad_perm:[0,1,2,3] row_mask:0x2 bank_mask:0xf
v_smfmac_f32_16x16x64_bf16 v[28:31], v[4:7], v[104:111], v8
ds_read_b128 v[72:75], v47 offset:12288
v_mov_b64 v[20:21], 0
v_smfmac_f32_16x16x64_bf16 v[16:19], v[0:3], v[112:119], v8
ds_read_b128 v[76:79], v44 offset:12288
v_add_f32_dpp v9, v24, v25 quad_perm:[0,1,2,3] row_mask:0x4 bank_mask:0xf
v_smfmac_f32_16x16x64_bf16 v[16:19], v[4:7], v[120:127], v8
ds_read_b128 v[80:83], v40 offset:16384
v_mov_b64 v[24:25], 0
v_smfmac_f32_16x16x64_bf16 v[20:23], v[0:3], v[128:135], v8
ds_read_b128 v[84:87], v46 offset:16384
v_add_f32_dpp v9, v28, v29 quad_perm:[0,1,2,3] row_mask:0x8 bank_mask:0xf
v_smfmac_f32_16x16x64_bf16 v[20:23], v[4:7], v[136:143], v8
ds_read_b128 v[88:91], v47 offset:16384
v_mov_b64 v[28:29], 0
v_smfmac_f32_16x16x64_bf16 v[24:27], v[0:3], v[144:151], v8
ds_read_b128 v[92:95], v44 offset:16384
v_add_f32_dpp v10, v16, v17 quad_perm:[0,1,2,3] row_mask:0x1 bank_mask:0xf
v_smfmac_f32_16x16x64_bf16 v[24:27], v[4:7], v[152:159], v8
ds_read_b128 v[96:99], v40 offset:20480
v_mov_b64 v[16:17], 0
v_smfmac_f32_16x16x64_bf16 v[28:31], v[0:3], v[160:167], v8
ds_read_b128 v[100:103], v46 offset:20480
v_add_f32_dpp v10, v20, v21 quad_perm:[0,1,2,3] row_mask:0x2 bank_mask:0xf
v_smfmac_f32_16x16x64_bf16 v[28:31], v[4:7], v[168:175], v8
ds_read_b128 v[104:107], v47 offset:20480
v_mov_b64 v[20:21], 0
v_smfmac_f32_16x16x64_bf16 v[16:19], v[0:3], v[176:183], v8
ds_read_b128 v[108:111], v44 offset:20480
v_add_f32_dpp v10, v24, v25 quad_perm:[0,1,2,3] row_mask:0x4 bank_mask:0xf
v_smfmac_f32_16x16x64_bf16 v[16:19], v[4:7], v[184:191], v8
ds_read_b128 v[112:115], v40 offset:24576
v_mov_b64 v[24:25], 0
s_waitcnt lgkmcnt(9)
s_cmp_eq_u32 s87, 0
s_cbranch_scc1 Lskp_51
s_add_u32 m0, s90, 8192
s_nop 0
buffer_load_dwordx4 v38, s[12:15], s34 offen offset:0 nt lds
buffer_load_dwordx4 v39, s[12:15], s34 offen offset:1024 nt lds
buffer_load_dwordx4 v38, s[12:15], s34 offen offset:2048 nt lds
buffer_load_dwordx4 v39, s[12:15], s34 offen offset:3072 nt lds
s_add_u32 s88, s34, 4096
s_add_u32 m0, s90, 12288
s_nop 0
buffer_load_dwordx4 v38, s[12:15], s88 offen offset:0 nt lds
buffer_load_dwordx4 v39, s[12:15], s88 offen offset:1024 nt lds
buffer_load_dwordx4 v38, s[12:15], s88 offen offset:2048 nt lds
buffer_load_dwordx4 v39, s[12:15], s88 offen offset:3072 nt lds
Lskp_51:
v_smfmac_f32_16x16x64_bf16 v[20:23], v[0:3], v[192:199], v8
ds_read_b128 v[116:119], v46 offset:24576
v_add_f32_dpp v10, v28, v29 quad_perm:[0,1,2,3] row_mask:0x8 bank_mask:0xf
v_smfmac_f32_16x16x64_bf16 v[20:23], v[4:7], v[200:207], v8
ds_read_b128 v[120:123], v47 offset:24576
v_mov_b64 v[28:29], 0
v_smfmac_f32_16x16x64_bf16 v[24:27], v[0:3], v[208:215], v8
ds_read_b128 v[124:127], v44 offset:24576
ds_read_b64_tr_b16 v[128:129], v41 offset:28672
v_add_f32_dpp v11, v16, v17 quad_perm:[0,1,2,3] row_mask:0x1 bank_mask:0xf
v_mov_b64 v[176:177], 0
v_smfmac_f32_16x16x64_bf16 v[24:27], v[4:7], v[216:223], v8
ds_read_b64_tr_b16 v[130:131], v41 offset:32768
v_mov_b64 v[16:17], 0
v_mov_b64 v[180:181], 0
v_smfmac_f32_16x16x64_bf16 v[28:31], v[0:3], v[224:231], v8
v_xor_b32 v46, 32, v41
ds_read_b64_tr_b16 v[132:133], v46 offset:28672
v_add_f32_dpp v11, v20, v21 quad_perm:[0,1,2,3] row_mask:0x2 bank_mask:0xf
v_mov_b64 v[184:185], 0
v_smfmac_f32_16x16x64_bf16 v[28:31], v[4:7], v[232:239], v8
ds_read_b64_tr_b16 v[134:135], v46 offset:32768
v_mov_b64 v[20:21], 0
v_mov_b64 v[188:189], 0
v_smfmac_f32_16x16x64_bf16 v[16:19], v[0:3], v[240:247], v8
v_xor_b32 v47, 64, v41
ds_read_b64_tr_b16 v[136:137], v47 offset:28672
v_add_f32_dpp v11, v24, v25 quad_perm:[0,1,2,3] row_mask:0x4 bank_mask:0xf
v_mov_b64 v[192:193], 0
v_smfmac_f32_16x16x64_bf16 v[16:19], v[4:7], v[248:255], v8
ds_read_b64_tr_b16 v[138:139], v47 offset:32768
v_mov_b64 v[24:25], 0
v_mov_b64 v[196:197], 0
v_smfmac_f32_16x16x64_bf16 v[20:23], v[0:3], v[48:55], v8
v_xor_b32 v46, 96, v41
ds_read_b64_tr_b16 v[140:141], v46 offset:28672
v_add_f32_dpp v11, v28, v29 quad_perm:[0,1,2,3] row_mask:0x8 bank_mask:0xf
v_mov_b64 v[200:201], 0
v_smfmac_f32_16x16x64_bf16 v[20:23], v[4:7], v[56:63], v8
ds_read_b64_tr_b16 v[142:143], v46 offset:32768
v_mov_b64 v[28:29], 0
v_mov_b64 v[204:205], 0
v_max3_f32 v42, v9, v10, v11
v_smfmac_f32_16x16x64_bf16 v[24:27], v[0:3], v[64:71], v8
v_xor_b32 v47, 128, v41
ds_read_b64_tr_b16 v[144:145], v47 offset:28672
v_add_f32_dpp v12, v16, v17 quad_perm:[0,1,2,3] row_mask:0x1 bank_mask:0xf
v_smfmac_f32_16x16x64_bf16 v[24:27], v[4:7], v[72:79], v8
ds_read_b64_tr_b16 v[146:147], v47 offset:32768
v_mov_b64 v[16:17], 0
s_waitcnt lgkmcnt(15)
v_smfmac_f32_16x16x64_bf16 v[28:31], v[0:3], v[80:87], v8
v_xor_b32 v46, 160, v41
ds_read_b64_tr_b16 v[148:149], v46 offset:28672
v_add_f32_dpp v12, v20, v21 quad_perm:[0,1,2,3] row_mask:0x2 bank_mask:0xf
v_smfmac_f32_16x16x64_bf16 v[28:31], v[4:7], v[88:95], v8
ds_read_b64_tr_b16 v[150:151], v46 offset:32768
v_mov_b64 v[20:21], 0
s_waitcnt lgkmcnt(15)
v_smfmac_f32_16x16x64_bf16 v[16:19], v[0:3], v[96:103], v8
v_xor_b32 v47, 192, v41
ds_read_b64_tr_b16 v[152:153], v47 offset:28672
v_add_f32_dpp v12, v24, v25 quad_perm:[0,1,2,3] row_mask:0x4 bank_mask:0xf
v_smfmac_f32_16x16x64_bf16 v[16:19], v[4:7], v[104:111], v8
ds_read_b64_tr_b16 v[154:155], v47 offset:32768
s_waitcnt lgkmcnt(14)
v_smfmac_f32_16x16x64_bf16 v[20:23], v[0:3], v[112:119], v8
v_xor_b32 v46, 224, v41
ds_read_b64_tr_b16 v[156:157], v46 offset:28672
v_add_f32_dpp v12, v28, v29 quad_perm:[0,1,2,3] row_mask:0x8 bank_mask:0xf
v_smfmac_f32_16x16x64_bf16 v[20:23], v[4:7], v[120:127], v8
ds_read_b64_tr_b16 v[158:159], v46 offset:32768
v_add_f32_dpp v13, v16, v17 quad_perm:[0,1,2,3] row_mask:0x1 bank_mask:0xf
s_nop 5
v_add_f32_dpp v13, v20, v21 quad_perm:[0,1,2,3] row_mask:0x2 bank_mask:0xf
v_max3_f32 v42, v42, v12, v13
s_nop 1
v_max_f32_dpp v42, v42, v42 row_ror:8 row_mask:0xf bank_mask:0xf
s_nop 1
v_max_f32_dpp v42, v42, v42 row_ror:4 row_mask:0xf bank_mask:0xf
s_nop 1
v_max_f32_dpp v42, v42, v42 row_ror:2 row_mask:0xf bank_mask:0xf
s_nop 1
v_max_f32_dpp v42, v42, v42 row_ror:1 row_mask:0xf bank_mask:0xf
v_mov_b32 v43, v42
s_nop 1
v_permlane16_swap_b32 v42, v43
v_max_f32 v42, v42, v43
v_mov_b32 v43, v42
s_nop 1
v_permlane32_swap_b32 v42, v43
v_max_f32 v42, v42, v43
v_sub_f32 v9, v9, v42
v_sub_f32 v10, v10, v42
v_sub_f32 v11, v11, v42
v_sub_f32 v12, v12, v42
v_sub_f32 v13, v13, v42
v_exp_f32 v9, v9
v_exp_f32 v10, v10
v_exp_f32 v11, v11
v_exp_f32 v12, v12
v_exp_f32 v13, v13
v_cvt_pk_bf16_f32 v16, v9, v10
v_cvt_pk_bf16_f32 v17, v11, v12
v_cvt_pk_bf16_f32 v18, v13, v13
ds_write_b16 v14, v16
ds_write_b16_d16_hi v14, v16 offset:128
ds_write_b16 v14, v17 offset:256
ds_write_b16_d16_hi v14, v17 offset:384
ds_write_b16 v14, v18 offset:512
ds_read_b128 v[208:211], v45 offset:0
ds_read_b128 v[212:215], v45 offset:128
ds_read_b128 v[216:219], v45 offset:256
ds_read_b128 v[220:223], v45 offset:384
ds_read_b128 v[224:227], v45 offset:512
v_add_f32 v9, v9, v10
v_add_f32 v11, v11, v12
v_add_f32 v9, v9, v13
v_add_f32 v43, v9, v11
s_lshl_b32 s89, s92, 2
s_add_u32 s89, s89, s3
s_mul_i32 s89, s89, 544
s_add_u32 s89, s89, 148736
v_mbcnt_lo_u32_b32 v46, -1, 0
v_mbcnt_hi_u32_b32 v46, -1, v46
v_lshl_add_u32 v46, v46, 2, s89
v_mov_b32 v47, s89
s_waitcnt lgkmcnt(4)
v_smfmac_f32_16x16x64_bf16 v[176:179], v[208:211], a[0:7], v8
v_smfmac_f32_16x16x64_bf16 v[180:183], v[208:211], a[8:15], v8
v_smfmac_f32_16x16x64_bf16 v[184:187], v[208:211], a[16:23], v8
v_add_f32_dpp v43, v43, v43 row_ror:8 row_mask:0xf bank_mask:0xf
v_smfmac_f32_16x16x64_bf16 v[188:191], v[208:211], a[24:31], v8
v_smfmac_f32_16x16x64_bf16 v[192:195], v[208:211], a[32:39], v8
v_smfmac_f32_16x16x64_bf16 v[196:199], v[208:211], a[40:47], v8
v_add_f32_dpp v43, v43, v43 row_ror:4 row_mask:0xf bank_mask:0xf
v_smfmac_f32_16x16x64_bf16 v[200:203], v[208:211], a[48:55], v8
v_smfmac_f32_16x16x64_bf16 v[204:207], v[208:211], a[56:63], v8
s_waitcnt lgkmcnt(3)
v_smfmac_f32_16x16x64_bf16 v[176:179], v[212:215], a[64:71], v8
v_add_f32_dpp v43, v43, v43 row_ror:2 row_mask:0xf bank_mask:0xf
v_smfmac_f32_16x16x64_bf16 v[180:183], v[212:215], a[72:79], v8
v_smfmac_f32_16x16x64_bf16 v[184:187], v[212:215], a[80:87], v8
v_smfmac_f32_16x16x64_bf16 v[188:191], v[212:215], a[88:95], v8
v_add_f32_dpp v43, v43, v43 row_ror:1 row_mask:0xf bank_mask:0xf
v_smfmac_f32_16x16x64_bf16 v[192:195], v[212:215], a[96:103], v8
v_smfmac_f32_16x16x64_bf16 v[196:199], v[212:215], a[104:111], v8
v_smfmac_f32_16x16x64_bf16 v[200:203], v[212:215], a[112:119], v8
v_add_f32_dpp v43, v43, v43 row_bcast:15 row_mask:0xa bank_mask:0xf
v_smfmac_f32_16x16x64_bf16 v[204:207], v[212:215], a[120:127], v8
s_waitcnt lgkmcnt(2)
v_smfmac_f32_16x16x64_bf16 v[176:179], v[216:219], a[128:135], v8
v_smfmac_f32_16x16x64_bf16 v[180:183], v[216:219], a[136:143], v8
v_add_f32_dpp v43, v43, v43 row_bcast:31 row_mask:0xc bank_mask:0xf
v_smfmac_f32_16x16x64_bf16 v[184:187], v[216:219], a[144:151], v8
v_smfmac_f32_16x16x64_bf16 v[188:191], v[216:219], a[152:159], v8
v_smfmac_f32_16x16x64_bf16 v[192:195], v[216:219], a[160:167], v8
v_smfmac_f32_16x16x64_bf16 v[196:199], v[216:219], a[168:175], v8
v_smfmac_f32_16x16x64_bf16 v[200:203], v[216:219], a[176:183], v8
v_smfmac_f32_16x16x64_bf16 v[204:207], v[216:219], a[184:191], v8
s_waitcnt lgkmcnt(1)
v_smfmac_f32_16x16x64_bf16 v[176:179], v[220:223], a[192:199], v8
v_smfmac_f32_16x16x64_bf16 v[180:183], v[220:223], a[200:207], v8
v_smfmac_f32_16x16x64_bf16 v[184:187], v[220:223], a[208:215], v8
v_smfmac_f32_16x16x64_bf16 v[188:191], v[220:223], a[216:223], v8
v_smfmac_f32_16x16x64_bf16 v[192:195], v[220:223], a[224:231], v8
v_smfmac_f32_16x16x64_bf16 v[196:199], v[220:223], a[232:239], v8
v_smfmac_f32_16x16x64_bf16 v[200:203], v[220:223], a[240:247], v8
v_smfmac_f32_16x16x64_bf16 v[204:207], v[220:223], a[248:255], v8
s_waitcnt lgkmcnt(0)
v_smfmac_f32_16x16x64_bf16 v[176:179], v[224:227], v[128:135], v8
v_smfmac_f32_16x16x64_bf16 v[180:183], v[224:227], v[132:139], v8
v_smfmac_f32_16x16x64_bf16 v[184:187], v[224:227], v[136:143], v8
v_smfmac_f32_16x16x64_bf16 v[188:191], v[224:227], v[140:147], v8
v_smfmac_f32_16x16x64_bf16 v[192:195], v[224:227], v[144:151], v8
v_smfmac_f32_16x16x64_bf16 v[196:199], v[224:227], v[148:155], v8
v_smfmac_f32_16x16x64_bf16 v[200:203], v[224:227], v[152:159], v8
v_smfmac_f32_16x16x64_bf16 v[204:207], v[224:227], v[156:163], v8
s_nop 0
v_add_f32_dpp v9, v176, v177 quad_perm:[0,1,2,3] row_mask:0x1 bank_mask:0xf
v_add_f32_dpp v9, v180, v181 quad_perm:[0,1,2,3] row_mask:0x2 bank_mask:0xf
v_add_f32_dpp v9, v184, v185 quad_perm:[0,1,2,3] row_mask:0x4 bank_mask:0xf
v_add_f32_dpp v9, v188, v189 quad_perm:[0,1,2,3] row_mask:0x8 bank_mask:0xf
v_add_f32_dpp v10, v192, v193 quad_perm:[0,1,2,3] row_mask:0x1 bank_mask:0xf
v_add_f32_dpp v10, v196, v197 quad_perm:[0,1,2,3] row_mask:0x2 bank_mask:0xf
v_add_f32_dpp v10, v200, v201 quad_perm:[0,1,2,3] row_mask:0x4 bank_mask:0xf
v_add_f32_dpp v10, v204, v205 quad_perm:[0,1,2,3] row_mask:0x8 bank_mask:0xf
ds_write_b32 v46, v9
ds_write_b32 v46, v10 offset:256
s_mov_b32 exec_lo, 0x0
s_mov_b32 exec_hi, 0x80000000
ds_write_b64 v47, v[42:43] offset:512
s_mov_b64 exec, -1
s_lshl_b32 s88, s92, 2
s_add_u32 s88, s88, 148480
v_mov_b32 v46, s88
v_mov_b32 v47, 1
s_waitcnt lgkmcnt(0)
s_mov_b32 exec_lo, 0x1
s_mov_b32 exec_hi, 0x0
ds_add_rtn_u32 v42, v46, v47
s_mov_b64 exec, -1
s_mul_i32 s84, s92, 2176
s_add_u32 s84, s84, 148736
v_mbcnt_lo_u32_b32 v43, -1, 0
v_mbcnt_hi_u32_b32 v43, -1, v43
s_lshl_b32 s89, s80, 3
s_add_u32 s89, s89, s82
s_mul_i32 s89, s89, 640
v_and_b32 v29, 31, v43
v_lshlrev_b32 v29, 4, v29
v_add_u32 v29, s84, v29
v_mov_b32 v30, s84
s_mul_i32 s91, s92, 196608
s_add_u32 s89, s89, s91
s_add_u32 s89, s89, 8192
v_lshlrev_b32 v44, 4, v43
s_mov_b32 s32, 0
s_mov_b32 s33, 1
s_waitcnt lgkmcnt(0)
v_readfirstlane_b32 s88, v42
s_cmp_lg_u32 s88, 3
s_cbranch_scc1 Lnopub_52
ds_read_b64 v[16:17], v30 offset:512
ds_read_b64 v[18:19], v30 offset:1056
ds_read_b64 v[20:21], v30 offset:1600
ds_read_b64 v[22:23], v30 offset:2144
ds_read_b128 v[0:3], v29 offset:0
ds_read_b128 v[4:7], v29 offset:544
ds_read_b128 v[8:11], v29 offset:1088
ds_read_b128 v[12:15], v29 offset:1632
s_waitcnt lgkmcnt(4)
v_max3_f32 v24, v16, v18, v20
v_max_f32 v24, v24, v22
v_sub_f32 v25, v16, v24
v_sub_f32 v26, v18, v24
v_sub_f32 v27, v20, v24
v_sub_f32 v28, v22, v24
v_exp_f32 v25, v25
v_exp_f32 v26, v26
v_exp_f32 v27, v27
v_exp_f32 v28, v28
v_mul_f32 v31, v25, v17
v_fmac_f32 v31, v26, v19
v_fmac_f32 v31, v27, v21
v_fmac_f32 v31, v28, v23
s_waitcnt lgkmcnt(3)
v_pk_mul_f32 v[0:1], v[24:25], v[0:1] op_sel:[1,0] op_sel_hi:[1,1]
v_pk_mul_f32 v[2:3], v[24:25], v[2:3] op_sel:[1,0] op_sel_hi:[1,1]
s_waitcnt lgkmcnt(2)
v_pk_fma_f32 v[0:1], v[26:27], v[4:5], v[0:1] op_sel:[0,0,0] op_sel_hi:[0,1,1]
v_pk_fma_f32 v[2:3], v[26:27], v[6:7], v[2:3] op_sel:[0,0,0] op_sel_hi:[0,1,1]
s_waitcnt lgkmcnt(1)
v_pk_fma_f32 v[0:1], v[26:27], v[8:9], v[0:1] op_sel:[1,0,0] op_sel_hi:[1,1,1]
v_pk_fma_f32 v[2:3], v[26:27], v[10:11], v[2:3] op_sel:[1,0,0] op_sel_hi:[1,1,1]
s_waitcnt lgkmcnt(0)
v_pk_fma_f32 v[0:1], v[28:29], v[12:13], v[0:1] op_sel:[0,0,0] op_sel_hi:[0,1,1]
v_pk_fma_f32 v[2:3], v[28:29], v[14:15], v[2:3] op_sel:[0,0,0] op_sel_hi:[0,1,1]
s_mov_b32 exec_lo, 0xffffffff
s_mov_b32 exec_hi, 0x1
v_cndmask_b32_e64 v0, v0, v24, s[32:33]
v_cndmask_b32_e64 v1, v1, v31, s[32:33]
buffer_store_dwordx4 v[0:3], v44, s[4:7], s89 offen sc1
s_mov_b64 exec, -1
Lnopub_52:
s_cmp_lg_u32 s83, 0
s_nop 1
s_cbranch_scc1 L_attn_end
v_mbcnt_lo_u32_b32 v46, -1, 0
v_mbcnt_hi_u32_b32 v46, -1, v46
v_lshrrev_b32 v46, 4, v46
v_lshlrev_b32 v46, 4, v46
v_add_u32 v46, 147456, v46
ds_read_b128 v[0:3], v46 offset:0
ds_read_b128 v[4:7], v46 offset:64
ds_read_b128 v[8:11], v46 offset:128
ds_read_b128 v[12:15], v46 offset:192
s_waitcnt lgkmcnt(0)
s_mov_b32 s83, 1
s_mov_b32 s85, 0
s_branch L_it
L_pub1:
s_lshl_b32 s89, s92, 2
s_add_u32 s89, s89, s3
s_mul_i32 s89, s89, 544
s_add_u32 s89, s89, 148736
v_mbcnt_lo_u32_b32 v2, -1, 0
v_mbcnt_hi_u32_b32 v2, -1, v2
v_mov_b32 v43, v37
s_nop 1
v_permlane16_swap_b32 v37, v43
v_add_f32 v37, v37, v43
v_mov_b32 v43, v37
s_nop 1
v_permlane32_swap_b32 v37, v43
v_add_f32 v37, v37, v43
v_and_b32 v0, 15, v2
v_lshlrev_b32 v0, 6, v0
v_lshrrev_b32 v1, 4, v2
v_lshlrev_b32 v1, 4, v1
v_add_u32 v0, v0, v1
v_add_u32 v0, s89, v0
v_mov_b32 v1, s89
s_mov_b32 exec_lo, 0xff00ff
s_mov_b32 exec_hi, 0xff00ff
ds_write_b128 v0, v[32:35]
s_mov_b32 exec_lo, 0x1
s_mov_b32 exec_hi, 0x0
ds_write_b64 v1, v[36:37] offset:512
s_mov_b64 exec, -1
s_lshl_b32 s88, s92, 2
s_add_u32 s88, s88, 148480
v_mov_b32 v46, s88
v_mov_b32 v47, 1
s_waitcnt lgkmcnt(0)
s_mov_b32 exec_lo, 0x1
s_mov_b32 exec_hi, 0x0
ds_add_rtn_u32 v42, v46, v47
s_mov_b64 exec, -1
s_mul_i32 s84, s92, 2176
s_add_u32 s84, s84, 148736
v_mbcnt_lo_u32_b32 v43, -1, 0
v_mbcnt_hi_u32_b32 v43, -1, v43
s_lshl_b32 s89, s80, 3
s_add_u32 s89, s89, s82
s_mul_i32 s89, s89, 640
v_and_b32 v29, 31, v43
v_lshlrev_b32 v29, 4, v29
v_add_u32 v29, s84, v29
v_mov_b32 v30, s84
s_mul_i32 s91, s92, 196608
s_add_u32 s89, s89, s91
s_add_u32 s89, s89, 8192
v_lshlrev_b32 v44, 4, v43
s_mov_b32 s32, 0
s_mov_b32 s33, 1
s_waitcnt lgkmcnt(0)
v_readfirstlane_b32 s88, v42
s_cmp_lg_u32 s88, 3
s_cbranch_scc1 Lnopub_53
ds_read_b64 v[16:17], v30 offset:512
ds_read_b64 v[18:19], v30 offset:1056
ds_read_b64 v[20:21], v30 offset:1600
ds_read_b64 v[22:23], v30 offset:2144
ds_read_b128 v[0:3], v29 offset:0
ds_read_b128 v[4:7], v29 offset:544
ds_read_b128 v[8:11], v29 offset:1088
ds_read_b128 v[12:15], v29 offset:1632
s_waitcnt lgkmcnt(4)
v_max3_f32 v24, v16, v18, v20
v_max_f32 v24, v24, v22
v_sub_f32 v25, v16, v24
v_sub_f32 v26, v18, v24
v_sub_f32 v27, v20, v24
v_sub_f32 v28, v22, v24
v_exp_f32 v25, v25
v_exp_f32 v26, v26
v_exp_f32 v27, v27
v_exp_f32 v28, v28
v_mul_f32 v31, v25, v17
v_fmac_f32 v31, v26, v19
v_fmac_f32 v31, v27, v21
v_fmac_f32 v31, v28, v23
s_waitcnt lgkmcnt(3)
v_pk_mul_f32 v[0:1], v[24:25], v[0:1] op_sel:[1,0] op_sel_hi:[1,1]
v_pk_mul_f32 v[2:3], v[24:25], v[2:3] op_sel:[1,0] op_sel_hi:[1,1]
s_waitcnt lgkmcnt(2)
v_pk_fma_f32 v[0:1], v[26:27], v[4:5], v[0:1] op_sel:[0,0,0] op_sel_hi:[0,1,1]
v_pk_fma_f32 v[2:3], v[26:27], v[6:7], v[2:3] op_sel:[0,0,0] op_sel_hi:[0,1,1]
s_waitcnt lgkmcnt(1)
v_pk_fma_f32 v[0:1], v[26:27], v[8:9], v[0:1] op_sel:[1,0,0] op_sel_hi:[1,1,1]
v_pk_fma_f32 v[2:3], v[26:27], v[10:11], v[2:3] op_sel:[1,0,0] op_sel_hi:[1,1,1]
s_waitcnt lgkmcnt(0)
v_pk_fma_f32 v[0:1], v[28:29], v[12:13], v[0:1] op_sel:[0,0,0] op_sel_hi:[0,1,1]
v_pk_fma_f32 v[2:3], v[28:29], v[14:15], v[2:3] op_sel:[0,0,0] op_sel_hi:[0,1,1]
s_mov_b32 exec_lo, 0xffffffff
s_mov_b32 exec_hi, 0x1
v_cndmask_b32_e64 v0, v0, v24, s[32:33]
v_cndmask_b32_e64 v1, v1, v31, s[32:33]
buffer_store_dwordx4 v[0:3], v44, s[4:7], s89 offen sc1
s_mov_b64 exec, -1
Lnopub_53:
s_cmp_eq_u32 s87, 0
s_nop 1
s_cbranch_scc1 L_retB
s_branch L_retA
L_attn_end:
s_waitcnt vmcnt(0)
s_endpgm
L_chain_entry:
L_chain_text:
s_load_dwordx16 s[16:31], s[0:1], 0
s_load_dwordx8 s[32:39], s[0:1], 64
s_load_dwordx2 s[40:41], s[0:1], 96
s_getpc_b64 s[98:99]
Lpc_54:
v_lshlrev_b32 v2, 7, v0
v_min_u32 v2, L_exit-L_chain_text-128, v2
s_sub_u32 s98, s98, Lpc_54-L_chain_text
s_subb_u32 s99, s99, 0
v_mov_b32 v3, s99
v_add_co_u32 v2, vcc, s98, v2
v_addc_co_u32 v3, vcc, 0, v3, vcc
global_load_dword a254, v[2:3], off
global_load_dword a255, v[2:3], off offset:64
v_lshrrev_b32 v1, 6, v0
s_nop 0
v_readfirstlane_b32 s3, v1
s_mov_b32 s81, 200000
s_waitcnt lgkmcnt(0)
s_mov_b32 s4, s40
s_mov_b32 s5, s41
s_mov_b32 s6, 0xf0000
s_mov_b32 s7, 0x20000
s_mov_b32 s8, s18
s_mov_b32 s9, s19
s_mov_b32 s10, 0x8000000
s_mov_b32 s11, 0x20000
s_mov_b32 s12, s20
s_mov_b32 s13, s21
s_mov_b32 s14, 0x8000000
s_mov_b32 s15, 0x20000
s_mov_b32 s44, s38
s_mov_b32 s45, s39
s_mov_b32 s46, 0x100
s_mov_b32 s47, 0x20000
s_mov_b32 s48, s22
s_mov_b32 s49, s23
s_mov_b32 s50, 0x400000
s_mov_b32 s51, 0x20000
s_mov_b32 s52, s24
s_mov_b32 s53, s25
s_mov_b32 s54, 0x400000
s_mov_b32 s55, 0x20000
s_mov_b32 s56, s28
s_mov_b32 s57, s29
s_mov_b32 s58, 0x1c0000
s_mov_b32 s59, 0x20000
s_mov_b32 s60, s32
s_mov_b32 s61, s33
s_mov_b32 s62, 0x1c0000
s_mov_b32 s63, 0x20000
s_mov_b32 s64, s16
s_mov_b32 s65, s17
s_mov_b32 s66, 0x800
s_mov_b32 s67, 0x20000
s_mov_b32 s68, s30
s_mov_b32 s69, s31
s_mov_b32 s70, 0xe00
s_mov_b32 s71, 0x20000
s_mov_b32 s72, s34
s_mov_b32 s73, s35
s_mov_b32 s74, 0x400
s_mov_b32 s75, 0x20000
s_mov_b32 s76, s36
s_mov_b32 s77, s37
s_mov_b32 s78, 0x800
s_mov_b32 s79, 0x20000
L_chain:
s_lshr_b32 s80, s2, 3
s_min_u32 s96, s80, 27
s_lshr_b32 s90, s80, 2
s_and_b32 s91, s80, 3
s_mul_i32 s89, s3, 36864
v_and_b32 v1, 63, v0
v_lshlrev_b32 v102, 2, v0
buffer_load_dword v9, v102, s[64:67], 0 offen offset:1024
buffer_load_dword v7, v102, s[64:67], 0 offen offset:0
s_lshl_b32 s87, s80, 2
s_add_u32 s87, s87, s3
s_mul_i32 s87, s87, 6144
v_lshlrev_b32 v37, 4, v1
v_mov_b32 v100, -1
v_mov_b32 v101, -1
v_mov_b32 v102, -1
v_mov_b32 v103, -1
buffer_store_dwordx4 v[100:103], v37, s[4:7], s87 offen offset:0 sc1
buffer_store_dwordx4 v[100:103], v37, s[4:7], s87 offen offset:1024 sc1
buffer_store_dwordx4 v[100:103], v37, s[4:7], s87 offen offset:2048 sc1
buffer_store_dwordx4 v[100:103], v37, s[4:7], s87 offen offset:3072 sc1
s_add_u32 s87, s87, 4096
buffer_store_dwordx4 v[100:103], v37, s[4:7], s87 offen offset:0 sc1
buffer_store_dwordx4 v[100:103], v37, s[4:7], s87 offen offset:1024 sc1
s_lshl_b32 s94, s80, 8
s_lshl_b32 s87, s3, 6
s_add_u32 s94, s94, s87
v_lshrrev_b32 v96, 4, v1
v_lshlrev_b32 v97, 1, v96
v_and_b32 v98, 15, v1
v_xor_b32 v97, v97, v98
v_mul_u32_u24 v96, 8192, v96
v_lshl_add_u32 v96, v97, 4, v96
v_xor_b32 v97, 0x80, v96
s_mul_i32 s88, s3, 524224
s_add_u32 s88, s88, s94
s_add_u32 s88, s88, 0
s_add_u32 s87, s89, 0
s_mov_b32 s92, 4
Lw64c_55:
s_mov_b32 m0, s87
s_nop 0
buffer_load_dwordx4 v96, s[48:51], s88 offen lds
s_add_u32 s87, s87, 1024
s_add_u32 s88, s88, 32768
s_mov_b32 m0, s87
s_nop 0
buffer_load_dwordx4 v96, s[48:51], s88 offen lds
s_add_u32 s87, s87, 1024
s_add_u32 s88, s88, 32768
s_mov_b32 m0, s87
s_nop 0
buffer_load_dwordx4 v97, s[48:51], s88 offen lds
s_add_u32 s87, s87, 1024
s_add_u32 s88, s88, 32768
s_mov_b32 m0, s87
s_nop 0
buffer_load_dwordx4 v97, s[48:51], s88 offen lds
s_add_u32 s87, s87, 1024
s_add_u32 s88, s88, 32768
s_sub_u32 s92, s92, 1
s_cmp_lg_u32 s92, 0
s_cbranch_scc1 Lw64c_55
s_lshl_b32 s86, s90, 19
s_lshl_b32 s87, s91, 2
s_add_u32 s87, s87, s3
s_lshl_b32 s87, s87, 6
s_add_u32 s86, s86, s87
v_lshrrev_b32 v97, 4, v1
v_lshlrev_b32 v29, 4, v97
v_lshlrev_b32 v32, 3, v97
v_add_u32 v2, 147456, v29
v_lshrrev_b32 v3, 3, v0
v_lshlrev_b32 v3, 5, v3
v_and_b32 v96, 1, v0
v_lshl_or_b32 v3, v96, 4, v3
v_bfe_u32 v96, v0, 1, 2
v_lshl_or_b32 v3, v96, 2, v3
v_add_u32 v3, 147456, v3
v_and_b32 v96, 1, v1
v_mul_u32_u24 v13, 0xaaaa, v96
v_add_u32 v13, 0x4444, v13
v_lshlrev_b32 v96, 4, v96
v_lshl_or_b32 v96, v97, 5, v96
v_add_u32 v10, 147456, v96
s_lshl_b32 s87, s3, 10
s_add_u32 s87, s87, 153600
v_add_u32 v14, s87, v96
v_and_b32 v11, 2, v1
v_cmp_ne_u32 vcc, 0, v11
v_add_u32 v11, 148480, v96
v_add_u32 v12, 149504, v96
v_mov_b32 v96, 160128
v_cndmask_b32 v11, v11, v96, vcc
v_cndmask_b32 v12, v12, v96, vcc
v_lshlrev_b32 v96, 2, v0
v_add_u32 v96, 160128, v96
v_mov_b32 v15, 0x3f803f80
ds_write_b32 v96, v15
v_bfe_u32 v16, v1, 1, 3
v_lshrrev_b32 v15, 3, v16
v_lshlrev_b32 v15, 5, v15
v_and_b32 v96, 1, v16
v_lshl_or_b32 v15, v96, 4, v15
v_bfe_u32 v96, v16, 1, 2
v_lshl_or_b32 v15, v96, 2, v15
v_bfe_u32 v17, v1, 4, 1
v_lshl_add_u32 v17, v17, 5, v15
v_lshrrev_b32 v16, 1, v1
v_lshlrev_b32 v16, 2, v16
v_lshlrev_b32 v18, 2, v1
v_lshlrev_b32 v4, 3, v0
v_add_u32 v5, 147456, v4
v_lshlrev_b32 v20, 4, v0
v_lshrrev_b32 v19, 1, v1
v_lshlrev_b32 v19, 4, v19
v_and_b32 v96, 1, v1
v_lshl_or_b32 v19, v96, 2, v19
v_lshrrev_b32 v97, 5, v1
v_mul_u32_u24 v97, 2560, v97
v_add_u32 v28, 512, v97
v_and_b32 v27, 31, v1
v_lshlrev_b32 v27, 4, v27
v_add_u32 v27, v27, v97
v_and_b32 v38, 31, v1
v_lshlrev_b32 v38, 1, v38
v_lshrrev_b32 v97, 5, v1
v_add_u32 v38, v38, v97
v_mov_b32 v97, v38
v_lshrrev_b32 v38, 3, v97
v_lshlrev_b32 v38, 5, v38
v_and_b32 v96, 1, v97
v_lshl_or_b32 v38, v96, 4, v38
v_bfe_u32 v96, v97, 1, 2
v_lshl_or_b32 v38, v96, 2, v38
s_lshl_b32 s87, s3, 8
s_add_u32 s87, s87, 147456
v_add_u32 v38, s87, v38
s_lshl_b32 s87, s3, 10
s_add_u32 s87, s87, 153600
v_add_u32 v33, s87, v37
v_add_u32 v34, s87, v29
v_and_b32 v39, 15, v1
v_lshlrev_b32 v39, 2, v39
v_add_u32 v36, 152640, v39
s_lshl_b32 s87, s3, 6
v_add_u32 v35, s87, v36
s_mov_b32 s16, 0x10001
s_mov_b32 s17, 0x10001
s_mov_b32 s18, 0x20002
s_mov_b32 s19, 0x20002
s_mov_b32 s20, 0x40004
s_mov_b32 s21, 0x40004
s_mov_b32 s22, 0x80008
s_mov_b32 s23, 0x80008
s_mov_b32 s24, 0x100010
s_mov_b32 s25, 0x100010
s_mov_b32 s26, 0x200020
s_mov_b32 s27, 0x200020
s_mov_b32 s28, 0x400040
s_mov_b32 s29, 0x400040
s_mov_b32 s30, 0x800080
s_mov_b32 s31, 0x800080
s_waitcnt vmcnt(16)
s_barrier
s_cmp_lg_u32 s3, 0
s_cbranch_scc1 Lnoarr_56
s_getreg_b32 s87, hwreg(HW_REG_XCC_ID)
s_and_b32 s87, s87, 15
s_mul_i32 s88, s87, s87
s_lshl_b32 s88, s88, 15
s_lshl_b32 s87, s87, 6
s_add_u32 s87, s87, s88
s_add_u32 s87, s87, 1
v_mov_b32 v100, s87
v_mov_b32 v101, 0
s_mov_b32 exec_lo, 0x1
s_mov_b32 exec_hi, 0x0
buffer_atomic_add v100, v101, s[44:47], 0 offen sc1
s_mov_b64 exec, -1
Lnoarr_56:
v_lshrrev_b32 v96, 4, v1
v_lshlrev_b32 v97, 1, v96
v_and_b32 v98, 15, v1
v_xor_b32 v97, v97, v98
v_mul_u32_u24 v96, 8192, v96
v_lshl_add_u32 v96, v97, 4, v96
v_xor_b32 v97, 0x80, v96
s_mul_i32 s88, s3, 524224
s_add_u32 s88, s88, s94
s_add_u32 s88, s88, 2097152
s_add_u32 s87, s89, 16384
s_mov_b32 s92, 4
Lw64c_57:
s_mov_b32 m0, s87
s_nop 0
buffer_load_dwordx4 v96, s[48:51], s88 offen lds
s_add_u32 s87, s87, 1024
s_add_u32 s88, s88, 32768
s_mov_b32 m0, s87
s_nop 0
buffer_load_dwordx4 v96, s[48:51], s88 offen lds
s_add_u32 s87, s87, 1024
s_add_u32 s88, s88, 32768
s_mov_b32 m0, s87
s_nop 0
buffer_load_dwordx4 v97, s[48:51], s88 offen lds
s_add_u32 s87, s87, 1024
s_add_u32 s88, s88, 32768
s_mov_b32 m0, s87
s_nop 0
buffer_load_dwordx4 v97, s[48:51], s88 offen lds
s_add_u32 s87, s87, 1024
s_add_u32 s88, s88, 32768
s_sub_u32 s92, s92, 1
s_cmp_lg_u32 s92, 0
s_cbranch_scc1 Lw64c_57
v_lshlrev_b32 v8, 16, v9
v_and_b32 v9, 0xffff0000, v9
v_lshlrev_b32 v6, 16, v7
v_and_b32 v7, 0xffff0000, v7
s_waitcnt vmcnt(16)
s_barrier
v_lshrrev_b32 v98, 4, v1
v_bfe_u32 v99, v1, 2, 2
v_lshl_add_u32 v96, v98, 3, v99
v_lshlrev_b32 v96, 8, v96
v_and_b32 v98, 1, v98
v_lshlrev_b32 v98, 3, v98
v_lshl_or_b32 v98, v99, 1, v98
v_bfe_u32 v99, v1, 1, 1
s_lshl_b32 s87, s3, 2
v_or_b32 v99, s87, v99
v_xor_b32 v98, v98, v99
v_lshl_add_u32 v96, v98, 4, v96
v_and_b32 v99, 1, v1
v_lshl_add_u32 v96, v99, 3, v96
v_xor_b32 v97, 32, v96
ds_read_b64_tr_b16 a[0:1], v96 offset:0
ds_read_b64_tr_b16 a[2:3], v96 offset:1024
ds_read_b64_tr_b16 a[64:65], v97 offset:0
ds_read_b64_tr_b16 a[66:67], v97 offset:1024
ds_read_b64_tr_b16 a[4:5], v96 offset:8192
ds_read_b64_tr_b16 a[6:7], v96 offset:9216
ds_read_b64_tr_b16 a[68:69], v97 offset:8192
ds_read_b64_tr_b16 a[70:71], v97 offset:9216
v_add_u32 v96, 36864, v96
v_add_u32 v97, 36864, v97
ds_read_b64_tr_b16 a[8:9], v96 offset:0
ds_read_b64_tr_b16 a[10:11], v96 offset:1024
ds_read_b64_tr_b16 a[72:73], v97 offset:0
ds_read_b64_tr_b16 a[74:75], v97 offset:1024
ds_read_b64_tr_b16 a[12:13], v96 offset:8192
ds_read_b64_tr_b16 a[14:15], v96 offset:9216
ds_read_b64_tr_b16 a[76:77], v97 offset:8192
ds_read_b64_tr_b16 a[78:79], v97 offset:9216
v_add_u32 v96, 36864, v96
v_add_u32 v97, 36864, v97
ds_read_b64_tr_b16 a[16:17], v96 offset:0
ds_read_b64_tr_b16 a[18:19], v96 offset:1024
ds_read_b64_tr_b16 a[80:81], v97 offset:0
ds_read_b64_tr_b16 a[82:83], v97 offset:1024
ds_read_b64_tr_b16 a[20:21], v96 offset:8192
ds_read_b64_tr_b16 a[22:23], v96 offset:9216
ds_read_b64_tr_b16 a[84:85], v97 offset:8192
ds_read_b64_tr_b16 a[86:87], v97 offset:9216
v_add_u32 v96, 36864, v96
v_add_u32 v97, 36864, v97
ds_read_b64_tr_b16 a[24:25], v96 offset:0
ds_read_b64_tr_b16 a[26:27], v96 offset:1024
ds_read_b64_tr_b16 a[88:89], v97 offset:0
ds_read_b64_tr_b16 a[90:91], v97 offset:1024
ds_read_b64_tr_b16 a[28:29], v96 offset:8192
ds_read_b64_tr_b16 a[30:31], v96 offset:9216
ds_read_b64_tr_b16 a[92:93], v97 offset:8192
ds_read_b64_tr_b16 a[94:95], v97 offset:9216
s_waitcnt lgkmcnt(0)
s_waitcnt vmcnt(0)
s_barrier
v_lshrrev_b32 v98, 4, v1
v_bfe_u32 v99, v1, 2, 2
v_lshl_add_u32 v96, v98, 3, v99
v_lshlrev_b32 v96, 8, v96
v_and_b32 v98, 1, v98
v_lshlrev_b32 v98, 3, v98
v_lshl_or_b32 v98, v99, 1, v98
v_bfe_u32 v99, v1, 1, 1
s_lshl_b32 s87, s3, 2
v_or_b32 v99, s87, v99
v_xor_b32 v98, v98, v99
v_lshl_add_u32 v96, v98, 4, v96
v_and_b32 v99, 1, v1
v_lshl_add_u32 v96, v99, 3, v96
v_xor_b32 v97, 32, v96
ds_read_b64_tr_b16 a[32:33], v96 offset:16384
ds_read_b64_tr_b16 a[34:35], v96 offset:17408
ds_read_b64_tr_b16 a[96:97], v97 offset:16384
ds_read_b64_tr_b16 a[98:99], v97 offset:17408
ds_read_b64_tr_b16 a[36:37], v96 offset:24576
ds_read_b64_tr_b16 a[38:39], v96 offset:25600
ds_read_b64_tr_b16 a[100:101], v97 offset:24576
ds_read_b64_tr_b16 a[102:103], v97 offset:25600
v_add_u32 v96, 36864, v96
v_add_u32 v97, 36864, v97
ds_read_b64_tr_b16 a[40:41], v96 offset:16384
ds_read_b64_tr_b16 a[42:43], v96 offset:17408
ds_read_b64_tr_b16 a[104:105], v97 offset:16384
ds_read_b64_tr_b16 a[106:107], v97 offset:17408
ds_read_b64_tr_b16 a[44:45], v96 offset:24576
ds_read_b64_tr_b16 a[46:47], v96 offset:25600
ds_read_b64_tr_b16 a[108:109], v97 offset:24576
ds_read_b64_tr_b16 a[110:111], v97 offset:25600
v_add_u32 v96, 36864, v96
v_add_u32 v97, 36864, v97
ds_read_b64_tr_b16 a[48:49], v96 offset:16384
ds_read_b64_tr_b16 a[50:51], v96 offset:17408
ds_read_b64_tr_b16 a[112:113], v97 offset:16384
ds_read_b64_tr_b16 a[114:115], v97 offset:17408
ds_read_b64_tr_b16 a[52:53], v96 offset:24576
ds_read_b64_tr_b16 a[54:55], v96 offset:25600
ds_read_b64_tr_b16 a[116:117], v97 offset:24576
ds_read_b64_tr_b16 a[118:119], v97 offset:25600
v_add_u32 v96, 36864, v96
v_add_u32 v97, 36864, v97
ds_read_b64_tr_b16 a[56:57], v96 offset:16384
ds_read_b64_tr_b16 a[58:59], v96 offset:17408
ds_read_b64_tr_b16 a[120:121], v97 offset:16384
ds_read_b64_tr_b16 a[122:123], v97 offset:17408
ds_read_b64_tr_b16 a[60:61], v96 offset:24576
ds_read_b64_tr_b16 a[62:63], v96 offset:25600
ds_read_b64_tr_b16 a[124:125], v97 offset:24576
ds_read_b64_tr_b16 a[126:127], v97 offset:25600
s_waitcnt lgkmcnt(0)
s_barrier
s_cmp_lg_u32 s3, 0
s_cbranch_scc1 Lna_58
buffer_load_dword v62, off, s[44:47], 0 sc1
Lna_58:
v_lshrrev_b32 v96, 4, v1
v_lshlrev_b32 v97, 1, v96
v_and_b32 v98, 15, v1
v_xor_b32 v97, v97, v98
v_mul_u32_u24 v96, 1024, v96
v_lshl_add_u32 v96, v97, 4, v96
v_xor_b32 v97, 0x80, v96
s_mul_i32 s88, s3, 65472
s_add_u32 s88, s88, s86
s_add_u32 s88, s88, 0
s_add_u32 s87, s89, 0
s_mov_b32 s92, 4
Lw64c_59:
s_mov_b32 m0, s87
s_nop 0
buffer_load_dwordx4 v96, s[52:55], s88 offen lds
s_add_u32 s87, s87, 1024
s_add_u32 s88, s88, 4096
s_mov_b32 m0, s87
s_nop 0
buffer_load_dwordx4 v96, s[52:55], s88 offen lds
s_add_u32 s87, s87, 1024
s_add_u32 s88, s88, 4096
s_mov_b32 m0, s87
s_nop 0
buffer_load_dwordx4 v97, s[52:55], s88 offen lds
s_add_u32 s87, s87, 1024
s_add_u32 s88, s88, 4096
s_mov_b32 m0, s87
s_nop 0
buffer_load_dwordx4 v97, s[52:55], s88 offen lds
s_add_u32 s87, s87, 1024
s_add_u32 s88, s88, 4096
s_sub_u32 s92, s92, 1
s_cmp_lg_u32 s92, 0
s_cbranch_scc1 Lw64c_59
s_cmp_lg_u32 s3, 0
s_cbranch_scc1 Lna_60
s_waitcnt vmcnt(16)
v_and_b32 v102, 63, v62
v_cmp_ne_u32 vcc, 32, v102
s_nop 1
s_cbranch_vccz Larrok_61
v_mov_b32 v101, 0
s_nop 1
Larr_62:
buffer_load_dword v62, v101, s[44:47], 0 offen sc1
s_waitcnt vmcnt(0)
v_and_b32 v102, 63, v62
v_cmp_ne_u32 vcc, 32, v102
s_nop 1
s_cbranch_vccz Larrd_63
s_sub_u32 s81, s81, 1
s_cbranch_scc0 Larr_62
s_mov_b32 s81, 0
Larrd_63:
Larrok_61:
v_mov_b32 v101, 153472
ds_write_b32 v101, v62
s_nop 0
Lna_60:
s_mov_b32 s84, 1
s_mov_b32 s95, 196608
v_mov_b32 v30, v8
v_mov_b32 v31, v9
v_mov_b64 v[52:53], 0
v_mov_b64 v[54:55], 0
v_mov_b64 v[56:57], 0
v_mov_b64 v[58:59], 0
s_lshl_b32 s88, s80, 8
s_lshl_b32 s92, s3, 6
s_add_u32 s88, s88, s92
s_add_u32 s93, s88, s95
s_lshl_b32 s88, s84, 8
s_add_u32 s92, s92, s88
s_add_u32 s92, s92, 152896
v_cvt_pk_bf16_f32 v98, v30, v31
v_add_f32 v96, v30, v31
v_mul_f32 v97, v30, v30
ds_write_b32 v3, v98 offset:2048
v_fmac_f32 v97, v31, v31
v_add_f32_dpp v96, v96, v96 row_shr:1 row_mask:0xf bank_mask:0xf
s_nop 0
v_add_f32_dpp v97, v97, v97 row_shr:1 row_mask:0xf bank_mask:0xf
v_add_f32_dpp v96, v96, v96 row_shr:2 row_mask:0xf bank_mask:0xf
s_nop 0
v_add_f32_dpp v97, v97, v97 row_shr:2 row_mask:0xf bank_mask:0xf
v_add_f32_dpp v96, v96, v96 row_shr:4 row_mask:0xf bank_mask:0xf
s_nop 0
v_add_f32_dpp v97, v97, v97 row_shr:4 row_mask:0xf bank_mask:0xf
v_add_f32_dpp v96, v96, v96 row_shr:8 row_mask:0xf bank_mask:0xf
s_nop 0
v_add_f32_dpp v97, v97, v97 row_shr:8 row_mask:0xf bank_mask:0xf
v_add_f32_dpp v96, v96, v96 row_bcast:15 row_mask:0xa bank_mask:0xf
s_nop 0
v_add_f32_dpp v97, v97, v97 row_bcast:15 row_mask:0xa bank_mask:0xf
v_add_f32_dpp v96, v96, v96 row_bcast:31 row_mask:0xc bank_mask:0xf
s_nop 0
v_add_f32_dpp v97, v97, v97 row_bcast:31 row_mask:0xc bank_mask:0xf
s_lshl_b32 s87, s3, 3
s_add_u32 s87, s87, 152608
v_mov_b32 v98, s87
s_mov_b32 exec_lo, 0x0
s_mov_b32 exec_hi, 0x80000000
ds_write_b64 v98, v[96:97]
s_mov_b64 exec, -1
s_waitcnt lgkmcnt(0)
s_barrier
v_mov_b32 v135, 147456
ds_read_b128 v[128:131], v135 offset:5152
ds_read_b128 v[60:63], v135 offset:5168
ds_read_b128 v[64:67], v12 offset:0
ds_read_b128 v[68:71], v12 offset:128
ds_read_b128 v[72:75], v12 offset:256
ds_read_b128 v[76:79], v12 offset:384
ds_read_b128 v[80:83], v12 offset:512
ds_read_b128 v[84:87], v12 offset:640
ds_read_b128 v[88:91], v12 offset:768
ds_read_b128 v[92:95], v12 offset:896
s_waitcnt lgkmcnt(8)
s_waitcnt lgkmcnt(7)
v_smfmac_f32_16x16x64_bf16 v[52:55], v[64:67], a[0:7], v13
v_add_f32 v128, v128, v130
v_smfmac_f32_16x16x64_bf16 v[56:59], v[64:67], a[64:71], v13
v_add_f32 v129, v129, v131
s_waitcnt lgkmcnt(6)
v_smfmac_f32_16x16x64_bf16 v[52:55], v[68:71], a[8:15], v13
v_add_f32 v60, v60, v62
v_smfmac_f32_16x16x64_bf16 v[56:59], v[68:71], a[72:79], v13
v_add_f32 v61, v61, v63
s_waitcnt lgkmcnt(5)
v_smfmac_f32_16x16x64_bf16 v[52:55], v[72:75], a[16:23], v13
v_add_f32 v128, v128, v60
v_smfmac_f32_16x16x64_bf16 v[56:59], v[72:75], a[80:87], v13
v_add_f32 v129, v129, v61
s_waitcnt lgkmcnt(4)
v_smfmac_f32_16x16x64_bf16 v[52:55], v[76:79], a[24:31], v13
v_mul_f32 v132, 0x3b000000, v128
v_smfmac_f32_16x16x64_bf16 v[56:59], v[76:79], a[88:95], v13
v_mul_f32 v129, 0x3b000000, v129
s_waitcnt lgkmcnt(3)
v_smfmac_f32_16x16x64_bf16 v[52:55], v[80:83], a[32:39], v13
v_fma_f32 v129, -v132, v132, v129
v_smfmac_f32_16x16x64_bf16 v[56:59], v[80:83], a[96:103], v13
v_add_f32 v129, 0x3727c5ac, v129
s_waitcnt lgkmcnt(2)
v_smfmac_f32_16x16x64_bf16 v[52:55], v[84:87], a[40:47], v13
v_max_f32 v129, 0x3727c5ac, v129
v_smfmac_f32_16x16x64_bf16 v[56:59], v[84:87], a[104:111], v13
v_rsq_f32 v133, v129
s_waitcnt lgkmcnt(1)
v_smfmac_f32_16x16x64_bf16 v[52:55], v[88:91], a[48:55], v13
v_mul_f32 v133, 0x3e0293ee, v133
v_smfmac_f32_16x16x64_bf16 v[56:59], v[88:91], a[112:119], v13
v_add_u32 v100, s92, v16
s_waitcnt lgkmcnt(0)
v_smfmac_f32_16x16x64_bf16 v[52:55], v[92:95], a[56:63], v13
v_smfmac_f32_16x16x64_bf16 v[56:59], v[92:95], a[120:127], v13
s_nop 6
v_add_f32_dpp v96, v52, v53 quad_perm:[0,1,2,3] row_mask:0x1 bank_mask:0xf
v_add_f32_dpp v97, v54, v55 quad_perm:[0,1,2,3] row_mask:0x1 bank_mask:0xf
v_add_f32_dpp v96, v56, v57 quad_perm:[0,1,2,3] row_mask:0x2 bank_mask:0xf
v_add_f32_dpp v97, v58, v59 quad_perm:[0,1,2,3] row_mask:0x2 bank_mask:0xf
v_fma_f32 v96, -v132, v97, v96
v_mul_f32 v96, v96, v133
s_nop 1
v_mov_b32_dpp v98, v96 quad_perm:[1,1,3,3] row_mask:0xf bank_mask:0xf
v_cvt_pk_bf16_f32 v96, v96, v98
s_mov_b32 exec_lo, 0x55555555
s_mov_b32 exec_hi, 0x0
buffer_store_dword v96, v16, s[4:7], s93 offen offset:0 sc1
ds_write_b32 v100, v96
s_mov_b64 exec, -1
s_mov_b32 s84, 0
s_mov_b32 s95, 0
v_mov_b32 v30, v6
v_mov_b32 v31, v7
v_mov_b64 v[52:53], 0
v_mov_b64 v[54:55], 0
v_mov_b64 v[56:57], 0
v_mov_b64 v[58:59], 0
s_lshl_b32 s88, s80, 8
s_lshl_b32 s92, s3, 6
s_add_u32 s88, s88, s92
s_add_u32 s93, s88, s95
s_lshl_b32 s88, s84, 8
s_add_u32 s92, s92, s88
s_add_u32 s92, s92, 152896
v_cvt_pk_bf16_f32 v98, v30, v31
v_add_f32 v96, v30, v31
v_mul_f32 v97, v30, v30
ds_write_b32 v3, v98 offset:1024
v_fmac_f32 v97, v31, v31
v_add_f32_dpp v96, v96, v96 row_shr:1 row_mask:0xf bank_mask:0xf
s_nop 0
v_add_f32_dpp v97, v97, v97 row_shr:1 row_mask:0xf bank_mask:0xf
v_add_f32_dpp v96, v96, v96 row_shr:2 row_mask:0xf bank_mask:0xf
s_nop 0
v_add_f32_dpp v97, v97, v97 row_shr:2 row_mask:0xf bank_mask:0xf
v_add_f32_dpp v96, v96, v96 row_shr:4 row_mask:0xf bank_mask:0xf
s_nop 0
v_add_f32_dpp v97, v97, v97 row_shr:4 row_mask:0xf bank_mask:0xf
v_add_f32_dpp v96, v96, v96 row_shr:8 row_mask:0xf bank_mask:0xf
s_nop 0
v_add_f32_dpp v97, v97, v97 row_shr:8 row_mask:0xf bank_mask:0xf
v_add_f32_dpp v96, v96, v96 row_bcast:15 row_mask:0xa bank_mask:0xf
s_nop 0
v_add_f32_dpp v97, v97, v97 row_bcast:15 row_mask:0xa bank_mask:0xf
v_add_f32_dpp v96, v96, v96 row_bcast:31 row_mask:0xc bank_mask:0xf
s_nop 0
v_add_f32_dpp v97, v97, v97 row_bcast:31 row_mask:0xc bank_mask:0xf
s_lshl_b32 s87, s3, 3
s_add_u32 s87, s87, 152576
v_mov_b32 v98, s87
s_mov_b32 exec_lo, 0x0
s_mov_b32 exec_hi, 0x80000000
ds_write_b64 v98, v[96:97]
s_mov_b64 exec, -1
s_waitcnt lgkmcnt(0)
s_barrier
v_mov_b32 v135, 147456
ds_read_b128 v[128:131], v135 offset:5120
ds_read_b128 v[60:63], v135 offset:5136
ds_read_b128 v[64:67], v11 offset:0
ds_read_b128 v[68:71], v11 offset:128
ds_read_b128 v[72:75], v11 offset:256
ds_read_b128 v[76:79], v11 offset:384
ds_read_b128 v[80:83], v11 offset:512
ds_read_b128 v[84:87], v11 offset:640
ds_read_b128 v[88:91], v11 offset:768
ds_read_b128 v[92:95], v11 offset:896
s_waitcnt lgkmcnt(8)
s_waitcnt lgkmcnt(7)
v_smfmac_f32_16x16x64_bf16 v[52:55], v[64:67], a[0:7], v13
v_add_f32 v128, v128, v130
v_smfmac_f32_16x16x64_bf16 v[56:59], v[64:67], a[64:71], v13
v_add_f32 v129, v129, v131
s_waitcnt lgkmcnt(6)
v_smfmac_f32_16x16x64_bf16 v[52:55], v[68:71], a[8:15], v13
v_add_f32 v60, v60, v62
v_smfmac_f32_16x16x64_bf16 v[56:59], v[68:71], a[72:79], v13
v_add_f32 v61, v61, v63
s_waitcnt lgkmcnt(5)
v_smfmac_f32_16x16x64_bf16 v[52:55], v[72:75], a[16:23], v13
v_add_f32 v128, v128, v60
v_smfmac_f32_16x16x64_bf16 v[56:59], v[72:75], a[80:87], v13
v_add_f32 v129, v129, v61
s_waitcnt lgkmcnt(4)
v_smfmac_f32_16x16x64_bf16 v[52:55], v[76:79], a[24:31], v13
v_mul_f32 v132, 0x3b000000, v128
v_smfmac_f32_16x16x64_bf16 v[56:59], v[76:79], a[88:95], v13
v_mul_f32 v129, 0x3b000000, v129
s_waitcnt lgkmcnt(3)
v_smfmac_f32_16x16x64_bf16 v[52:55], v[80:83], a[32:39], v13
v_fma_f32 v129, -v132, v132, v129
v_smfmac_f32_16x16x64_bf16 v[56:59], v[80:83], a[96:103], v13
v_add_f32 v129, 0x3727c5ac, v129
s_waitcnt lgkmcnt(2)
v_smfmac_f32_16x16x64_bf16 v[52:55], v[84:87], a[40:47], v13
v_max_f32 v129, 0x3727c5ac, v129
v_smfmac_f32_16x16x64_bf16 v[56:59], v[84:87], a[104:111], v13
v_rsq_f32 v133, v129
s_waitcnt lgkmcnt(1)
v_smfmac_f32_16x16x64_bf16 v[52:55], v[88:91], a[48:55], v13
v_mul_f32 v133, 0x3e0293ee, v133
v_smfmac_f32_16x16x64_bf16 v[56:59], v[88:91], a[112:119], v13
v_add_u32 v100, s92, v16
s_waitcnt lgkmcnt(0)
v_smfmac_f32_16x16x64_bf16 v[52:55], v[92:95], a[56:63], v13
v_smfmac_f32_16x16x64_bf16 v[56:59], v[92:95], a[120:127], v13
s_nop 6
v_add_f32_dpp v96, v52, v53 quad_perm:[0,1,2,3] row_mask:0x1 bank_mask:0xf
v_add_f32_dpp v97, v54, v55 quad_perm:[0,1,2,3] row_mask:0x1 bank_mask:0xf
v_add_f32_dpp v96, v56, v57 quad_perm:[0,1,2,3] row_mask:0x2 bank_mask:0xf
v_add_f32_dpp v97, v58, v59 quad_perm:[0,1,2,3] row_mask:0x2 bank_mask:0xf
v_fma_f32 v96, -v132, v97, v96
v_mul_f32 v96, v96, v133
s_nop 1
v_mov_b32_dpp v98, v96 quad_perm:[1,1,3,3] row_mask:0xf bank_mask:0xf
v_cvt_pk_bf16_f32 v96, v96, v98
s_mov_b32 exec_lo, 0x55555555
s_mov_b32 exec_hi, 0x0
buffer_store_dword v96, v16, s[4:7], s93 offen offset:0 sc1
ds_write_b32 v100, v96
s_mov_b64 exec, -1
v_lshrrev_b32 v96, 4, v1
v_lshlrev_b32 v97, 1, v96
v_and_b32 v98, 15, v1
v_xor_b32 v97, v97, v98
v_mul_u32_u24 v96, 1024, v96
v_lshl_add_u32 v96, v97, 4, v96
v_xor_b32 v97, 0x80, v96
s_mul_i32 s88, s3, 65472
s_add_u32 s88, s88, s86
s_add_u32 s88, s88, 262144
s_add_u32 s87, s89, 16384
s_mov_b32 s92, 4
Lw64c_64:
s_mov_b32 m0, s87
s_nop 0
buffer_load_dwordx4 v96, s[52:55], s88 offen lds
s_add_u32 s87, s87, 1024
s_add_u32 s88, s88, 4096
s_mov_b32 m0, s87
s_nop 0
buffer_load_dwordx4 v96, s[52:55], s88 offen lds
s_add_u32 s87, s87, 1024
s_add_u32 s88, s88, 4096
s_mov_b32 m0, s87
s_nop 0
buffer_load_dwordx4 v97, s[52:55], s88 offen lds
s_add_u32 s87, s87, 1024
s_add_u32 s88, s88, 4096
s_mov_b32 m0, s87
s_nop 0
buffer_load_dwordx4 v97, s[52:55], s88 offen lds
s_add_u32 s87, s87, 1024
s_add_u32 s88, s88, 4096
s_sub_u32 s92, s92, 1
s_cmp_lg_u32 s92, 0
s_cbranch_scc1 Lw64c_64
v_mov_b32 v101, 153472
ds_read_b32 v62, v101
s_waitcnt lgkmcnt(0)
v_readfirstlane_b32 s87, v62
s_bfe_u32 s88, s87, 589830
s_lshr_b32 s87, s87, 15
s_lshl_b32 s87, s87, 5
s_mul_i32 s88, s88, s88
s_cmp_eq_u32 s87, s88
s_cselect_b32 s34, 1, 0
s_waitcnt vmcnt(18)
s_barrier
v_lshrrev_b32 v98, 4, v1
v_bfe_u32 v99, v1, 2, 2
v_lshl_add_u32 v96, v98, 3, v99
v_lshlrev_b32 v96, 8, v96
v_and_b32 v98, 1, v98
v_lshlrev_b32 v98, 3, v98
v_lshl_or_b32 v98, v99, 1, v98
v_bfe_u32 v99, v1, 1, 1
s_lshl_b32 s87, s3, 2
v_or_b32 v99, s87, v99
v_xor_b32 v98, v98, v99
v_lshl_add_u32 v96, v98, 4, v96
v_and_b32 v99, 1, v1
v_lshl_add_u32 v96, v99, 3, v96
v_xor_b32 v97, 32, v96
ds_read_b64_tr_b16 a[128:129], v96 offset:0
ds_read_b64_tr_b16 a[130:131], v96 offset:1024
ds_read_b64_tr_b16 a[192:193], v97 offset:0
ds_read_b64_tr_b16 a[194:195], v97 offset:1024
ds_read_b64_tr_b16 a[132:133], v96 offset:8192
ds_read_b64_tr_b16 a[134:135], v96 offset:9216
ds_read_b64_tr_b16 a[196:197], v97 offset:8192
ds_read_b64_tr_b16 a[198:199], v97 offset:9216
v_add_u32 v96, 36864, v96
v_add_u32 v97, 36864, v97
ds_read_b64_tr_b16 a[136:137], v96 offset:0
ds_read_b64_tr_b16 a[138:139], v96 offset:1024
ds_read_b64_tr_b16 a[200:201], v97 offset:0
ds_read_b64_tr_b16 a[202:203], v97 offset:1024
ds_read_b64_tr_b16 a[140:141], v96 offset:8192
ds_read_b64_tr_b16 a[142:143], v96 offset:9216
ds_read_b64_tr_b16 a[204:205], v97 offset:8192
ds_read_b64_tr_b16 a[206:207], v97 offset:9216
v_add_u32 v96, 36864, v96
v_add_u32 v97, 36864, v97
ds_read_b64_tr_b16 a[144:145], v96 offset:0
ds_read_b64_tr_b16 a[146:147], v96 offset:1024
ds_read_b64_tr_b16 a[208:209], v97 offset:0
ds_read_b64_tr_b16 a[210:211], v97 offset:1024
ds_read_b64_tr_b16 a[148:149], v96 offset:8192
ds_read_b64_tr_b16 a[150:151], v96 offset:9216
ds_read_b64_tr_b16 a[212:213], v97 offset:8192
ds_read_b64_tr_b16 a[214:215], v97 offset:9216
v_add_u32 v96, 36864, v96
v_add_u32 v97, 36864, v97
ds_read_b64_tr_b16 a[152:153], v96 offset:0
ds_read_b64_tr_b16 a[154:155], v96 offset:1024
ds_read_b64_tr_b16 a[216:217], v97 offset:0
ds_read_b64_tr_b16 a[218:219], v97 offset:1024
ds_read_b64_tr_b16 a[156:157], v96 offset:8192
ds_read_b64_tr_b16 a[158:159], v96 offset:9216
ds_read_b64_tr_b16 a[220:221], v97 offset:8192
ds_read_b64_tr_b16 a[222:223], v97 offset:9216
s_waitcnt lgkmcnt(0)
s_barrier
v_lshrrev_b32 v96, 3, v1
v_mul_u32_u24 v96, 3584, v96
v_and_b32 v97, 7, v1
v_lshlrev_b32 v97, 4, v97
v_add_u32 v96, v96, v97
s_lshl_b32 s88, s96, 7
s_mul_i32 s92, s3, 458752
s_add_u32 s88, s88, s92
s_mov_b32 s87, s89
s_mov_b32 s92, 16
Lw1_65:
s_mov_b32 m0, s87
s_nop 0
buffer_load_dwordx4 v96, s[56:59], s88 offen lds
s_add_u32 s87, s87, 1024
s_add_u32 s88, s88, 28672
s_sub_u32 s92, s92, 1
s_cmp_lg_u32 s92, 0
s_cbranch_scc1 Lw1_65
s_waitcnt vmcnt(16)
s_barrier
v_lshrrev_b32 v98, 4, v1
v_bfe_u32 v99, v1, 2, 2
v_lshl_add_u32 v96, v98, 3, v99
v_lshlrev_b32 v96, 8, v96
v_and_b32 v98, 1, v98
v_lshlrev_b32 v98, 3, v98
v_lshl_or_b32 v98, v99, 1, v98
v_bfe_u32 v99, v1, 1, 1
s_lshl_b32 s87, s3, 2
v_or_b32 v99, s87, v99
v_xor_b32 v98, v98, v99
v_lshl_add_u32 v96, v98, 4, v96
v_and_b32 v99, 1, v1
v_lshl_add_u32 v96, v99, 3, v96
v_xor_b32 v97, 32, v96
ds_read_b64_tr_b16 a[160:161], v96 offset:16384
ds_read_b64_tr_b16 a[162:163], v96 offset:17408
ds_read_b64_tr_b16 a[224:225], v97 offset:16384
ds_read_b64_tr_b16 a[226:227], v97 offset:17408
ds_read_b64_tr_b16 a[164:165], v96 offset:24576
ds_read_b64_tr_b16 a[166:167], v96 offset:25600
ds_read_b64_tr_b16 a[228:229], v97 offset:24576
ds_read_b64_tr_b16 a[230:231], v97 offset:25600
v_add_u32 v96, 36864, v96
v_add_u32 v97, 36864, v97
ds_read_b64_tr_b16 a[168:169], v96 offset:16384
ds_read_b64_tr_b16 a[170:171], v96 offset:17408
ds_read_b64_tr_b16 a[232:233], v97 offset:16384
ds_read_b64_tr_b16 a[234:235], v97 offset:17408
ds_read_b64_tr_b16 a[172:173], v96 offset:24576
ds_read_b64_tr_b16 a[174:175], v96 offset:25600
ds_read_b64_tr_b16 a[236:237], v97 offset:24576
ds_read_b64_tr_b16 a[238:239], v97 offset:25600
v_add_u32 v96, 36864, v96
v_add_u32 v97, 36864, v97
ds_read_b64_tr_b16 a[176:177], v96 offset:16384
ds_read_b64_tr_b16 a[178:179], v96 offset:17408
ds_read_b64_tr_b16 a[240:241], v97 offset:16384
ds_read_b64_tr_b16 a[242:243], v97 offset:17408
ds_read_b64_tr_b16 a[180:181], v96 offset:24576
ds_read_b64_tr_b16 a[182:183], v96 offset:25600
ds_read_b64_tr_b16 a[244:245], v97 offset:24576
ds_read_b64_tr_b16 a[246:247], v97 offset:25600
v_add_u32 v96, 36864, v96
v_add_u32 v97, 36864, v97
ds_read_b64_tr_b16 a[184:185], v96 offset:16384
ds_read_b64_tr_b16 a[186:187], v96 offset:17408
ds_read_b64_tr_b16 a[248:249], v97 offset:16384
ds_read_b64_tr_b16 a[250:251], v97 offset:17408
ds_read_b64_tr_b16 a[188:189], v96 offset:24576
ds_read_b64_tr_b16 a[190:191], v96 offset:25600
ds_read_b64_tr_b16 a[252:253], v97 offset:24576
ds_read_b64_tr_b16 a[254:255], v97 offset:25600
s_waitcnt lgkmcnt(0)
s_barrier
v_lshrrev_b32 v96, 1, v1
v_mul_u32_u24 v96, 1024, v96
v_and_b32 v97, 1, v1
v_lshlrev_b32 v97, 4, v97
v_add_u32 v96, v96, v97
s_mul_i32 s88, s3, 458752
s_lshl_b32 s93, s80, 5
s_add_u32 s88, s88, s93
s_add_u32 s87, s89, 16384
s_mov_b32 s92, 14
Lw2_66:
s_mov_b32 m0, s87
s_nop 0
buffer_load_dwordx4 v96, s[60:63], s88 offen lds
s_add_u32 s87, s87, 1024
s_add_u32 s88, s88, 32768
s_sub_u32 s92, s92, 1
s_cmp_lg_u32 s92, 0
s_cbranch_scc1 Lw2_66
s_lshl_b32 s87, s96, 2
s_add_u32 s87, s87, s3
s_lshl_b32 s87, s87, 5
v_lshrrev_b32 v98, 1, v39
buffer_load_ushort v22, v98, s[68:71], s87 offen
s_lshl_b32 s88, s80, 5
buffer_load_ushort v26, v98, s[72:75], s88 offen
v_lshrrev_b32 v99, 4, v1
v_lshlrev_b32 v100, 1, v99
v_and_b32 v86, 15, v1
v_xor_b32 v86, v86, v100
v_lshlrev_b32 v86, 4, v86
v_lshlrev_b32 v99, 8, v99
v_add_u32 v86, v86, v99
v_xor_b32 v87, 0x80, v86
s_waitcnt vmcnt(16)
s_barrier
v_lshrrev_b32 v96, 4, v1
v_lshlrev_b32 v96, 3, v96
v_bfe_u32 v97, v1, 2, 2
v_add_u32 v96, v96, v97
v_lshlrev_b32 v96, 7, v96
v_and_b32 v97, 3, v1
v_lshlrev_b32 v97, 3, v97
v_add_u32 v96, v96, v97
s_lshl_b32 s87, s3, 5
v_add_u32 v96, s87, v96
ds_read_b64_tr_b16 v[192:193], v96 offset:0
ds_read_b64_tr_b16 v[194:195], v96 offset:512
ds_read_b64_tr_b16 v[196:197], v96 offset:4096
ds_read_b64_tr_b16 v[198:199], v96 offset:4608
ds_read_b64_tr_b16 v[200:201], v96 offset:8192
ds_read_b64_tr_b16 v[202:203], v96 offset:8704
ds_read_b64_tr_b16 v[204:205], v96 offset:12288
ds_read_b64_tr_b16 v[206:207], v96 offset:12800
v_add_u32 v96, 36864, v96
ds_read_b64_tr_b16 v[208:209], v96 offset:0
ds_read_b64_tr_b16 v[210:211], v96 offset:512
ds_read_b64_tr_b16 v[212:213], v96 offset:4096
ds_read_b64_tr_b16 v[214:215], v96 offset:4608
ds_read_b64_tr_b16 v[216:217], v96 offset:8192
ds_read_b64_tr_b16 v[218:219], v96 offset:8704
ds_read_b64_tr_b16 v[220:221], v96 offset:12288
ds_read_b64_tr_b16 v[222:223], v96 offset:12800
v_add_u32 v96, 36864, v96
ds_read_b64_tr_b16 v[224:225], v96 offset:0
ds_read_b64_tr_b16 v[226:227], v96 offset:512
ds_read_b64_tr_b16 v[228:229], v96 offset:4096
ds_read_b64_tr_b16 v[230:231], v96 offset:4608
ds_read_b64_tr_b16 v[232:233], v96 offset:8192
ds_read_b64_tr_b16 v[234:235], v96 offset:8704
ds_read_b64_tr_b16 v[236:237], v96 offset:12288
ds_read_b64_tr_b16 v[238:239], v96 offset:12800
v_add_u32 v96, 36864, v96
ds_read_b64_tr_b16 v[240:241], v96 offset:0
ds_read_b64_tr_b16 v[242:243], v96 offset:512
ds_read_b64_tr_b16 v[244:245], v96 offset:4096
ds_read_b64_tr_b16 v[246:247], v96 offset:4608
ds_read_b64_tr_b16 v[248:249], v96 offset:8192
ds_read_b64_tr_b16 v[250:251], v96 offset:8704
ds_read_b64_tr_b16 v[252:253], v96 offset:12288
ds_read_b64_tr_b16 v[254:255], v96 offset:12800
s_waitcnt lgkmcnt(0)
s_barrier
s_add_u32 s87, s3, 252
s_lshl_b32 s87, s87, 13
s_lshl_b32 s88, s80, 21
s_add_u32 s87, s87, s88
s_add_u32 s92, s87, 67108864
s_add_u32 s93, s89, 0
s_mov_b32 m0, s93
s_nop 0
buffer_load_dwordx4 v86, s[8:11], s92 offen offset:0 nt lds
buffer_load_dwordx4 v87, s[8:11], s92 offen offset:1024 nt lds
buffer_load_dwordx4 v86, s[8:11], s92 offen offset:2048 nt lds
buffer_load_dwordx4 v87, s[8:11], s92 offen offset:3072 nt lds
s_add_u32 s92, s87, 67112960
s_add_u32 s93, s89, 4096
s_mov_b32 m0, s93
s_nop 0
buffer_load_dwordx4 v86, s[8:11], s92 offen offset:0 nt lds
buffer_load_dwordx4 v87, s[8:11], s92 offen offset:1024 nt lds
buffer_load_dwordx4 v86, s[8:11], s92 offen offset:2048 nt lds
buffer_load_dwordx4 v87, s[8:11], s92 offen offset:3072 nt lds
s_add_u32 s92, s87, 67108864
s_add_u32 s93, s89, 8192
s_mov_b32 m0, s93
s_nop 0
buffer_load_dwordx4 v86, s[12:15], s92 offen offset:0 nt lds
buffer_load_dwordx4 v87, s[12:15], s92 offen offset:1024 nt lds
buffer_load_dwordx4 v86, s[12:15], s92 offen offset:2048 nt lds
buffer_load_dwordx4 v87, s[12:15], s92 offen offset:3072 nt lds
s_add_u32 s92, s87, 67112960
s_add_u32 s93, s89, 12288
s_mov_b32 m0, s93
s_nop 0
buffer_load_dwordx4 v86, s[12:15], s92 offen offset:0 nt lds
buffer_load_dwordx4 v87, s[12:15], s92 offen offset:1024 nt lds
buffer_load_dwordx4 v86, s[12:15], s92 offen offset:2048 nt lds
buffer_load_dwordx4 v87, s[12:15], s92 offen offset:3072 nt lds
s_waitcnt vmcnt(18)
v_lshrrev_b32 v96, 4, v1
v_lshlrev_b32 v96, 3, v96
v_bfe_u32 v97, v1, 2, 2
v_add_u32 v96, v96, v97
v_lshlrev_b32 v96, 5, v96
v_and_b32 v97, 3, v1
v_lshlrev_b32 v97, 3, v97
v_add_u32 v96, v96, v97
v_add_u32 v96, s89, v96
ds_read_b64_tr_b16 v[136:137], v96 offset:16384
ds_read_b64_tr_b16 v[138:139], v96 offset:16512
ds_read_b64_tr_b16 v[140:141], v96 offset:17408
ds_read_b64_tr_b16 v[142:143], v96 offset:17536
ds_read_b64_tr_b16 v[144:145], v96 offset:18432
ds_read_b64_tr_b16 v[146:147], v96 offset:18560
ds_read_b64_tr_b16 v[148:149], v96 offset:19456
ds_read_b64_tr_b16 v[150:151], v96 offset:19584
ds_read_b64_tr_b16 v[152:153], v96 offset:20480
ds_read_b64_tr_b16 v[154:155], v96 offset:20608
ds_read_b64_tr_b16 v[156:157], v96 offset:21504
ds_read_b64_tr_b16 v[158:159], v96 offset:21632
ds_read_b64_tr_b16 v[160:161], v96 offset:22528
ds_read_b64_tr_b16 v[162:163], v96 offset:22656
ds_read_b64_tr_b16 v[164:165], v96 offset:23552
ds_read_b64_tr_b16 v[166:167], v96 offset:23680
ds_read_b64_tr_b16 v[168:169], v96 offset:24576
ds_read_b64_tr_b16 v[170:171], v96 offset:24704
ds_read_b64_tr_b16 v[172:173], v96 offset:25600
ds_read_b64_tr_b16 v[174:175], v96 offset:25728
ds_read_b64_tr_b16 v[176:177], v96 offset:26624
ds_read_b64_tr_b16 v[178:179], v96 offset:26752
ds_read_b64_tr_b16 v[180:181], v96 offset:27648
ds_read_b64_tr_b16 v[182:183], v96 offset:27776
ds_read_b64_tr_b16 v[184:185], v96 offset:28672
ds_read_b64_tr_b16 v[186:187], v96 offset:28800
ds_read_b64_tr_b16 v[188:189], v96 offset:29696
ds_read_b64_tr_b16 v[190:191], v96 offset:29824
s_waitcnt lgkmcnt(0)
s_waitcnt vmcnt(16)
v_lshlrev_b32 v22, 16, v22
v_lshlrev_b32 v26, 16, v26
s_waitcnt vmcnt(0)
s_mov_b32 s84, 1
s_mov_b32 s94, 196608
s_waitcnt lgkmcnt(0)
s_barrier
s_lshl_b32 s87, s84, 8
v_add_u32 v96, s87, v2
ds_read_b128 v[52:55], v96 offset:5440
ds_read_b128 v[56:59], v96 offset:5504
ds_read_b128 v[60:63], v96 offset:5568
ds_read_b128 v[64:67], v96 offset:5632
s_xor_b32 s88, s84, 1
s_lshl_b32 s88, s88, 14
s_add_u32 s88, s88, s89
v_and_b32 v82, 15, v1
v_and_b32 v83, 7, v1
v_lshlrev_b32 v83, 1, v83
v_lshrrev_b32 v41, 4, v1
v_xor_b32 v83, v83, v41
v_lshlrev_b32 v83, 4, v83
v_lshlrev_b32 v82, 8, v82
v_add_u32 v82, v82, v83
v_add_u32 v40, s88, v82
v_xor_b32 v41, 64, v40
v_xor_b32 v42, 128, v40
v_xor_b32 v43, 192, v40
v_lshrrev_b32 v82, 2, v1
v_and_b32 v83, 7, v82
v_lshlrev_b32 v83, 1, v83
v_lshlrev_b32 v82, 8, v82
v_bfe_u32 v45, v1, 1, 1
v_xor_b32 v83, v83, v45
v_lshlrev_b32 v83, 4, v83
v_add_u32 v82, v82, v83
v_and_b32 v83, 1, v1
v_lshlrev_b32 v83, 3, v83
v_add_u32 v82, v82, v83
v_add_u32 v44, s88, v82
v_xor_b32 v45, 32, v44
v_xor_b32 v46, 64, v44
v_xor_b32 v47, 96, v44
v_xor_b32 v48, 128, v44
v_xor_b32 v49, 160, v44
v_xor_b32 v50, 192, v44
v_xor_b32 v51, 224, v44
v_mov_b32 v80, 0xff800000
v_mov_b32 v81, 0
v_mov_b32 v76, 0
v_mov_b32 v77, 0
v_mov_b32 v78, 0
v_mov_b32 v79, 0
s_waitcnt lgkmcnt(0)
ds_read_b128 v[96:99], v40 offset:0
ds_read_b128 v[100:103], v41 offset:0
ds_read_b128 v[104:107], v42 offset:0
ds_read_b128 v[108:111], v43 offset:0
ds_read_b128 v[112:115], v40 offset:4096
ds_read_b128 v[116:119], v41 offset:4096
ds_read_b128 v[120:123], v42 offset:4096
ds_read_b128 v[124:127], v43 offset:4096
s_waitcnt lgkmcnt(7)
v_mfma_f32_16x16x32_bf16 v[68:71], v[96:99], v[52:55], 0
s_waitcnt lgkmcnt(6)
v_mfma_f32_16x16x32_bf16 v[68:71], v[100:103], v[56:59], v[68:71]
s_waitcnt lgkmcnt(5)
v_mfma_f32_16x16x32_bf16 v[68:71], v[104:107], v[60:63], v[68:71]
s_waitcnt lgkmcnt(4)
v_mfma_f32_16x16x32_bf16 v[68:71], v[108:111], v[64:67], v[68:71]
s_waitcnt lgkmcnt(3)
v_mfma_f32_16x16x32_bf16 v[72:75], v[112:115], v[52:55], 0
s_waitcnt lgkmcnt(2)
v_mfma_f32_16x16x32_bf16 v[72:75], v[116:119], v[56:59], v[72:75]
s_waitcnt lgkmcnt(1)
v_mfma_f32_16x16x32_bf16 v[72:75], v[120:123], v[60:63], v[72:75]
s_waitcnt lgkmcnt(0)
v_mfma_f32_16x16x32_bf16 v[72:75], v[124:127], v[64:67], v[72:75]
ds_read_b64_tr_b16 v[96:97], v44 offset:8192
ds_read_b64_tr_b16 v[98:99], v44 offset:12288
ds_read_b64_tr_b16 v[100:101], v45 offset:8192
ds_read_b64_tr_b16 v[102:103], v45 offset:12288
ds_read_b64_tr_b16 v[104:105], v46 offset:8192
ds_read_b64_tr_b16 v[106:107], v46 offset:12288
ds_read_b64_tr_b16 v[108:109], v47 offset:8192
ds_read_b64_tr_b16 v[110:111], v47 offset:12288
ds_read_b64_tr_b16 v[112:113], v48 offset:8192
ds_read_b64_tr_b16 v[114:115], v48 offset:12288
ds_read_b64_tr_b16 v[116:117], v49 offset:8192
ds_read_b64_tr_b16 v[118:119], v49 offset:12288
ds_read_b64_tr_b16 v[120:121], v50 offset:8192
ds_read_b64_tr_b16 v[122:123], v50 offset:12288
ds_read_b64_tr_b16 v[124:125], v51 offset:8192
ds_read_b64_tr_b16 v[126:127], v51 offset:12288
v_max3_f32 v82, v68, v69, v70
v_max3_f32 v83, v72, v73, v74
v_max3_f32 v82, v82, v71, v75
v_max3_f32 v82, v82, v83, v80
v_mov_b32 v83, v82
s_nop 1
v_permlane16_swap_b32 v82, v83
v_max_f32 v82, v82, v83
v_mov_b32 v83, v82
s_nop 1
v_permlane32_swap_b32 v82, v83
v_max_f32 v82, v82, v83
v_sub_f32 v83, v80, v82
v_exp_f32 v83, v83
v_mov_b32 v80, v82
v_sub_f32 v68, v68, v82
v_sub_f32 v69, v69, v82
v_sub_f32 v70, v70, v82
v_sub_f32 v71, v71, v82
v_sub_f32 v72, v72, v82
v_sub_f32 v73, v73, v82
v_sub_f32 v74, v74, v82
v_sub_f32 v75, v75, v82
v_exp_f32 v68, v68
v_exp_f32 v69, v69
v_exp_f32 v70, v70
v_exp_f32 v71, v71
v_exp_f32 v72, v72
v_exp_f32 v73, v73
v_exp_f32 v74, v74
v_exp_f32 v75, v75
v_mul_f32 v81, v81, v83
v_mul_f32 v76, v76, v83
v_mul_f32 v77, v77, v83
v_mul_f32 v78, v78, v83
v_mul_f32 v79, v79, v83
v_add_f32 v84, v68, v69
v_add_f32 v85, v70, v71
v_add_f32 v84, v84, v72
v_add_f32 v85, v85, v73
v_add_f32 v84, v84, v74
v_add_f32 v85, v85, v75
v_add_f32 v81, v81, v84
v_add_f32 v81, v81, v85
v_cvt_pk_bf16_f32 v68, v68, v69
v_cvt_pk_bf16_f32 v69, v70, v71
v_cvt_pk_bf16_f32 v70, v72, v73
v_cvt_pk_bf16_f32 v71, v74, v75
v_cndmask_b32_e64 v88, 0, v68, s[16:17]
v_cndmask_b32_e64 v89, 0, v69, s[16:17]
v_cndmask_b32_e64 v90, 0, v70, s[16:17]
v_cndmask_b32_e64 v91, 0, v71, s[16:17]
v_cndmask_b32_e64 v92, 0, v68, s[18:19]
v_cndmask_b32_e64 v93, 0, v69, s[18:19]
v_cndmask_b32_e64 v94, 0, v70, s[18:19]
v_cndmask_b32_e64 v95, 0, v71, s[18:19]
s_waitcnt lgkmcnt(14)
v_mfma_f32_16x16x32_bf16 v[76:79], v[96:99], v[88:91], v[76:79]
v_cndmask_b32_e64 v88, 0, v68, s[20:21]
v_cndmask_b32_e64 v89, 0, v69, s[20:21]
v_cndmask_b32_e64 v90, 0, v70, s[20:21]
v_cndmask_b32_e64 v91, 0, v71, s[20:21]
s_waitcnt lgkmcnt(12)
v_mfma_f32_16x16x32_bf16 v[76:79], v[100:103], v[92:95], v[76:79]
v_cndmask_b32_e64 v92, 0, v68, s[22:23]
v_cndmask_b32_e64 v93, 0, v69, s[22:23]
v_cndmask_b32_e64 v94, 0, v70, s[22:23]
v_cndmask_b32_e64 v95, 0, v71, s[22:23]
s_waitcnt lgkmcnt(10)
v_mfma_f32_16x16x32_bf16 v[76:79], v[104:107], v[88:91], v[76:79]
v_cndmask_b32_e64 v88, 0, v68, s[24:25]
v_cndmask_b32_e64 v89, 0, v69, s[24:25]
v_cndmask_b32_e64 v90, 0, v70, s[24:25]
v_cndmask_b32_e64 v91, 0, v71, s[24:25]
s_waitcnt lgkmcnt(8)
v_mfma_f32_16x16x32_bf16 v[76:79], v[108:111], v[92:95], v[76:79]
v_cndmask_b32_e64 v92, 0, v68, s[26:27]
v_cndmask_b32_e64 v93, 0, v69, s[26:27]
v_cndmask_b32_e64 v94, 0, v70, s[26:27]
v_cndmask_b32_e64 v95, 0, v71, s[26:27]
s_waitcnt lgkmcnt(6)
v_mfma_f32_16x16x32_bf16 v[76:79], v[112:115], v[88:91], v[76:79]
v_cndmask_b32_e64 v88, 0, v68, s[28:29]
v_cndmask_b32_e64 v89, 0, v69, s[28:29]
v_cndmask_b32_e64 v90, 0, v70, s[28:29]
v_cndmask_b32_e64 v91, 0, v71, s[28:29]
s_waitcnt lgkmcnt(4)
v_mfma_f32_16x16x32_bf16 v[76:79], v[116:119], v[92:95], v[76:79]
v_cndmask_b32_e64 v92, 0, v68, s[30:31]
v_cndmask_b32_e64 v93, 0, v69, s[30:31]
v_cndmask_b32_e64 v94, 0, v70, s[30:31]
v_cndmask_b32_e64 v95, 0, v71, s[30:31]
s_waitcnt lgkmcnt(2)
v_mfma_f32_16x16x32_bf16 v[76:79], v[120:123], v[88:91], v[76:79]
s_waitcnt lgkmcnt(0)
v_mfma_f32_16x16x32_bf16 v[76:79], v[124:127], v[92:95], v[76:79]
s_mul_i32 s87, s3, 544
s_add_u32 s87, s87, 157696
v_mov_b32 v83, v81
s_nop 1
v_permlane16_swap_b32 v81, v83
v_add_f32 v81, v81, v83
v_mov_b32 v83, v81
s_nop 1
v_permlane32_swap_b32 v81, v83
v_add_f32 v81, v81, v83
v_and_b32 v96, 15, v1
v_lshlrev_b32 v96, 6, v96
v_lshrrev_b32 v97, 4, v1
v_lshlrev_b32 v97, 4, v97
v_add_u32 v96, v96, v97
v_add_u32 v96, s87, v96
v_mov_b32 v97, s87
s_mov_b32 exec_lo, 0xff00ff
s_mov_b32 exec_hi, 0xff00ff
ds_write_b128 v96, v[76:79]
s_mov_b32 exec_lo, 0x1
s_mov_b32 exec_hi, 0x0
ds_write_b64 v97, v[80:81] offset:512
s_mov_b64 exec, -1
s_waitcnt lgkmcnt(0)
s_barrier
s_cmp_lg_u32 s3, 0
s_cbranch_scc1 Lnp_67
s_lshl_b32 s88, s80, 3
s_add_u32 s88, s88, 7
s_mul_i32 s88, s88, 640
s_add_u32 s88, s88, s94
s_add_u32 s88, s88, 8192
s_mov_b32 s87, 157696
v_and_b32 v125, 31, v1
v_lshlrev_b32 v125, 4, v125
v_add_u32 v125, s87, v125
v_mov_b32 v126, s87
ds_read_b64 v[112:113], v126 offset:512
ds_read_b64 v[114:115], v126 offset:1056
ds_read_b64 v[116:117], v126 offset:1600
ds_read_b64 v[118:119], v126 offset:2144
ds_read_b128 v[96:99], v125 offset:0
ds_read_b128 v[100:103], v125 offset:544
ds_read_b128 v[104:107], v125 offset:1088
ds_read_b128 v[108:111], v125 offset:1632
s_waitcnt lgkmcnt(4)
v_max3_f32 v120, v112, v114, v116
v_max_f32 v120, v120, v118
v_sub_f32 v121, v112, v120
v_sub_f32 v122, v114, v120
v_sub_f32 v123, v116, v120
v_sub_f32 v124, v118, v120
v_exp_f32 v121, v121
v_exp_f32 v122, v122
v_exp_f32 v123, v123
v_exp_f32 v124, v124
v_mul_f32 v127, v121, v113
v_fmac_f32 v127, v122, v115
v_fmac_f32 v127, v123, v117
v_fmac_f32 v127, v124, v119
s_waitcnt lgkmcnt(0)
v_mul_f32 v96, v121, v96
v_mul_f32 v97, v121, v97
v_mul_f32 v98, v121, v98
v_mul_f32 v99, v121, v99
v_fmac_f32 v96, v122, v100
v_fmac_f32 v97, v122, v101
v_fmac_f32 v98, v122, v102
v_fmac_f32 v99, v122, v103
v_fmac_f32 v96, v123, v104
v_fmac_f32 v97, v123, v105
v_fmac_f32 v98, v123, v106
v_fmac_f32 v99, v123, v107
v_fmac_f32 v96, v124, v108
v_fmac_f32 v97, v124, v109
v_fmac_f32 v98, v124, v110
v_fmac_f32 v99, v124, v111
s_mov_b32 s32, 0
s_mov_b32 s33, 1
v_cndmask_b32_e64 v96, v96, v120, s[32:33]
v_cndmask_b32_e64 v97, v97, v127, s[32:33]
v_cndmask_b32_e64 v98, v98, 0, s[32:33]
v_cndmask_b32_e64 v99, v99, 0, s[32:33]
v_lshlrev_b32 v125, 4, v1
s_mov_b32 exec_lo, 0xffffffff
s_mov_b32 exec_hi, 0x1
buffer_store_dwordx4 v[96:99], v125, s[4:7], s88 offen sc1
s_mov_b64 exec, -1
s_nop 0
Lnp_67:
s_mov_b32 s66, 0xc0135761
s_mov_b32 s67, 0xbdd2d3e8
s_cmp_lt_u32 s80, 28
s_cselect_b32 s60, 0x5555, 0
s_mov_b32 s61, 0
s_cmp_eq_u32 s3, 0
s_cselect_b32 s62, 0xffff, 0
s_mov_b32 s63, 0
s_mov_b32 s64, -1
s_mov_b32 s65, 0
s_lshl_b32 s87, s3, 3
s_add_u32 s87, s87, 147456
v_mov_b32 v21, s87
v_mov_b32 v23, 147456
s_lshl_b32 s87, s80, 6
v_add_u32 v24, s87, v36
v_add_u32 v24, 4294965184, v24
v_lshrrev_b32 v25, 1, v39
s_cmp_eq_u32 s34, 0
s_nop 0
s_cbranch_scc1 L_cslow
s_mov_b32 s82, 0
L_cloop_f:
s_lshl_b32 s87, s82, 2
s_lshr_b32 s83, 0x2031, s87
s_and_b32 s83, s83, 3
s_and_b32 s84, s83, 1
s_lshr_b32 s85, s83, 1
s_mul_i32 s86, s83, 196608
s_cmp_eq_u32 s84, 0
s_cbranch_scc0 Lrx_68
v_mov_b32 v30, v6
v_mov_b32 v31, v7
s_nop 1
s_branch Lrxe_69
Lrx_68:
v_mov_b32 v30, v8
v_mov_b32 v31, v9
s_nop 1
Lrxe_69:
s_cmp_lg_u32 s3, 0
s_cbranch_scc1 Lpt_70
s_mul_i32 s87, s80, 768
s_add_u32 s87, s87, s86
s_add_u32 s87, s87, 172032
v_lshlrev_b32 v96, 7, v1
s_mov_b32 exec_lo, 0x3f
s_mov_b32 exec_hi, 0x0
buffer_load_dword v97, v96, s[4:7], s87 offen
s_mov_b64 exec, -1
Lpt_70:
s_lshl_b32 s59, s90, 2
s_add_u32 s59, s59, s3
s_mul_i32 s59, s59, 5120
s_add_u32 s59, s59, s86
s_add_u32 s59, s59, 8192
s_lshr_b32 s87, s90, 1
s_lshl_b32 s87, s87, 12
s_and_b32 s88, s90, 1
s_lshl3_add_u32 s87, s88, s87
s_add_u32 s49, s86, 172032
s_add_u32 s87, s87, s49
s_lshl_b32 s88, s91, 2
s_add_u32 s88, s88, s3
s_lshl_b32 s88, s88, 8
s_add_u32 s48, s87, s88
s_add_u32 s50, s49, 4096
s_add_u32 s51, s49, 8192
s_add_u32 s52, s49, 12288
s_lshl_b32 s53, s80, 2
s_add_u32 s53, s53, s3
s_lshl_b32 s53, s53, 5
s_add_u32 s54, s86, 188416
s_add_u32 s53, s53, s54
s_mul_i32 s87, s3, 896
s_add_u32 s54, s54, s87
s_add_u32 s56, s86, 192512
s_lshl_b32 s55, s80, 6
s_add_u32 s55, s55, s56
s_add_u32 s94, s86, 393216
s_lshl_b32 s57, s80, 8
s_lshl_b32 s87, s3, 6
s_add_u32 s57, s57, s87
s_add_u32 s57, s57, s94
s_lshl_b32 s88, s84, 8
s_add_u32 s58, s87, s88
s_add_u32 s58, s58, 152896
s_lshl_b32 s68, s84, 10
s_lshl_b32 s88, s80, 5
s_add_u32 s68, s68, s88
v_mov_b64 v[128:129], 0
v_mov_b64 v[132:133], 0
v_mov_b64 v[56:57], 0
v_mov_b64 v[58:59], 0
buffer_load_dwordx4 v[64:67], v27, s[4:7], s59 offen offset:0 sc1
buffer_load_dwordx2 v[80:81], v28, s[4:7], s59 offen offset:0 sc1
buffer_load_dwordx4 v[68:71], v27, s[4:7], s59 offen offset:640 sc1
buffer_load_dwordx2 v[82:83], v28, s[4:7], s59 offen offset:640 sc1
buffer_load_dwordx4 v[72:75], v27, s[4:7], s59 offen offset:1280 sc1
buffer_load_dwordx2 v[84:85], v28, s[4:7], s59 offen offset:1280 sc1
buffer_load_dwordx4 v[76:79], v27, s[4:7], s59 offen offset:1920 sc1
buffer_load_dwordx2 v[86:87], v28, s[4:7], s59 offen offset:1920 sc1
Lpoll_71:
s_waitcnt vmcnt(0)
v_max3_u32 v88, v64, v65, v66
v_max3_u32 v88, v88, v67, v80
v_max_u32 v88, v88, v81
v_max3_u32 v89, v68, v69, v70
v_max3_u32 v89, v89, v71, v82
v_max_u32 v89, v89, v83
v_max3_u32 v90, v72, v73, v74
v_max3_u32 v90, v90, v75, v84
v_max_u32 v90, v90, v85
v_max3_u32 v91, v76, v77, v78
v_max3_u32 v91, v91, v79, v86
v_max_u32 v91, v91, v87
v_max3_u32 v92, v88, v89, v90
v_max_u32 v92, v92, v91
v_cmp_eq_u32 vcc, -1, v92
s_nop 1
s_cbranch_vccz Lpdone_72
s_sub_u32 s81, s81, 1
s_cbranch_scc1 Lpbud_73
v_cmp_eq_u32 vcc, -1, v88
s_nop 1
s_cbranch_vccz Lpsk_74
buffer_load_dwordx4 v[64:67], v27, s[4:7], s59 offen offset:0 sc1
buffer_load_dwordx2 v[80:81], v28, s[4:7], s59 offen offset:0 sc1
Lpsk_74:
v_cmp_eq_u32 vcc, -1, v89
s_nop 1
s_cbranch_vccz Lpsk_75
buffer_load_dwordx4 v[68:71], v27, s[4:7], s59 offen offset:640 sc1
buffer_load_dwordx2 v[82:83], v28, s[4:7], s59 offen offset:640 sc1
Lpsk_75:
v_cmp_eq_u32 vcc, -1, v90
s_nop 1
s_cbranch_vccz Lpsk_76
buffer_load_dwordx4 v[72:75], v27, s[4:7], s59 offen offset:1280 sc1
buffer_load_dwordx2 v[84:85], v28, s[4:7], s59 offen offset:1280 sc1
Lpsk_76:
v_cmp_eq_u32 vcc, -1, v91
s_nop 1
s_cbranch_vccz Lpsk_77
buffer_load_dwordx4 v[76:79], v27, s[4:7], s59 offen offset:1920 sc1
buffer_load_dwordx2 v[86:87], v28, s[4:7], s59 offen offset:1920 sc1
Lpsk_77:
s_branch Lpoll_71
Lpbud_73:
s_mov_b32 s81, 0
Lpdone_72:
v_max3_f32 v88, v80, v82, v84
v_max_f32 v88, v88, v86
v_mov_b32 v94, v88
s_nop 1
v_permlane32_swap_b32 v88, v94
v_max_f32 v88, v88, v94
v_sub_f32 v89, v80, v88
v_sub_f32 v90, v82, v88
v_sub_f32 v91, v84, v88
v_sub_f32 v92, v86, v88
v_exp_f32 v89, v89
v_exp_f32 v90, v90
v_exp_f32 v91, v91
v_exp_f32 v92, v92
v_mul_f32 v93, v89, v81
v_pk_mul_f32 v[64:65], v[88:89], v[64:65] op_sel:[1,0] op_sel_hi:[1,1]
v_pk_mul_f32 v[66:67], v[88:89], v[66:67] op_sel:[1,0] op_sel_hi:[1,1]
v_fmac_f32 v93, v90, v83
v_pk_fma_f32 v[64:65], v[90:91], v[68:69], v[64:65] op_sel:[0,0,0] op_sel_hi:[0,1,1]
v_pk_fma_f32 v[66:67], v[90:91], v[70:71], v[66:67] op_sel:[0,0,0] op_sel_hi:[0,1,1]
v_fmac_f32 v93, v91, v85
v_pk_fma_f32 v[64:65], v[90:91], v[72:73], v[64:65] op_sel:[1,0,0] op_sel_hi:[1,1,1]
v_pk_fma_f32 v[66:67], v[90:91], v[74:75], v[66:67] op_sel:[1,0,0] op_sel_hi:[1,1,1]
v_fmac_f32 v93, v92, v87
v_pk_fma_f32 v[64:65], v[92:93], v[76:77], v[64:65] op_sel:[0,0,0] op_sel_hi:[0,1,1]
v_pk_fma_f32 v[66:67], v[92:93], v[78:79], v[66:67] op_sel:[0,0,0] op_sel_hi:[0,1,1]
v_mov_b32 v94, v93
s_nop 0
v_permlane32_swap_b32 v64, v66
v_permlane32_swap_b32 v93, v94
v_permlane32_swap_b32 v65, v67
v_add_f32 v93, v93, v94
v_pk_add_f32 v[64:65], v[64:65], v[66:67]
v_rcp_f32 v93, v93
s_nop 0
v_mul_f32 v64, v64, v93
v_mul_f32 v65, v65, v93
v_cvt_pk_bf16_f32 v64, v64, v65
ds_write_b32 v38, v64 offset:0
s_waitcnt lgkmcnt(0)
s_barrier
ds_read_b128 v[64:67], v10 offset:0
ds_read_b128 v[68:71], v10 offset:128
ds_read_b128 v[72:75], v10 offset:256
ds_read_b128 v[76:79], v10 offset:384
ds_read_b128 v[80:83], v10 offset:512
ds_read_b128 v[84:87], v10 offset:640
ds_read_b128 v[88:91], v10 offset:768
ds_read_b128 v[92:95], v10 offset:896
s_waitcnt lgkmcnt(7)
v_smfmac_f32_16x16x64_bf16 v[128:131], v[64:67], a[128:135], v13
v_smfmac_f32_16x16x64_bf16 v[132:135], v[64:67], a[192:199], v13
s_waitcnt lgkmcnt(6)
v_smfmac_f32_16x16x64_bf16 v[128:131], v[68:71], a[136:143], v13
v_smfmac_f32_16x16x64_bf16 v[132:135], v[68:71], a[200:207], v13
s_waitcnt lgkmcnt(5)
v_smfmac_f32_16x16x64_bf16 v[128:131], v[72:75], a[144:151], v13
v_smfmac_f32_16x16x64_bf16 v[132:135], v[72:75], a[208:215], v13
s_waitcnt lgkmcnt(4)
v_smfmac_f32_16x16x64_bf16 v[128:131], v[76:79], a[152:159], v13
v_smfmac_f32_16x16x64_bf16 v[132:135], v[76:79], a[216:223], v13
s_waitcnt lgkmcnt(3)
v_smfmac_f32_16x16x64_bf16 v[128:131], v[80:83], a[160:167], v13
v_smfmac_f32_16x16x64_bf16 v[132:135], v[80:83], a[224:231], v13
s_waitcnt lgkmcnt(2)
v_smfmac_f32_16x16x64_bf16 v[128:131], v[84:87], a[168:175], v13
v_smfmac_f32_16x16x64_bf16 v[132:135], v[84:87], a[232:239], v13
s_waitcnt lgkmcnt(1)
v_smfmac_f32_16x16x64_bf16 v[128:131], v[88:91], a[176:183], v13
v_smfmac_f32_16x16x64_bf16 v[132:135], v[88:91], a[240:247], v13
s_waitcnt lgkmcnt(0)
v_smfmac_f32_16x16x64_bf16 v[128:131], v[92:95], a[184:191], v13
v_smfmac_f32_16x16x64_bf16 v[132:135], v[92:95], a[248:255], v13
s_mov_b64 exec, s[64:65]
s_nop 5
v_add_f32_dpp v64, v128, v129 quad_perm:[0,1,2,3] row_mask:0x1 bank_mask:0xf
v_add_f32_dpp v64, v132, v133 quad_perm:[0,1,2,3] row_mask:0x2 bank_mask:0xf
buffer_store_dword v64, v19, s[4:7], s48 offen
s_mov_b64 exec, -1
buffer_load_dwordx4 v[64:67], v20, s[4:7], s49 offen sc1
buffer_load_dwordx4 v[68:71], v20, s[4:7], s50 offen sc1
buffer_load_dwordx4 v[72:75], v20, s[4:7], s51 offen sc1
buffer_load_dwordx4 v[76:79], v20, s[4:7], s52 offen sc1
Lpoll_78:
s_waitcnt vmcnt(0)
v_max3_u32 v80, v64, v65, v66
v_max_u32 v80, v80, v67
v_max3_u32 v81, v68, v69, v70
v_max_u32 v81, v81, v71
v_max3_u32 v82, v72, v73, v74
v_max_u32 v82, v82, v75
v_max3_u32 v83, v76, v77, v78
v_max_u32 v83, v83, v79
v_max3_u32 v84, v80, v81, v82
v_max_u32 v84, v84, v83
v_cmp_eq_u32 vcc, -1, v84
s_nop 1
s_cbranch_vccz Lpdone_79
s_sub_u32 s81, s81, 1
s_cbranch_scc1 Lpbud_80
v_cmp_eq_u32 vcc, -1, v80
s_nop 1
s_cbranch_vccz Lpsk_81
buffer_load_dwordx4 v[64:67], v20, s[4:7], s49 offen sc1
Lpsk_81:
v_cmp_eq_u32 vcc, -1, v81
s_nop 1
s_cbranch_vccz Lpsk_82
buffer_load_dwordx4 v[68:71], v20, s[4:7], s50 offen sc1
Lpsk_82:
v_cmp_eq_u32 vcc, -1, v82
s_nop 1
s_cbranch_vccz Lpsk_83
buffer_load_dwordx4 v[72:75], v20, s[4:7], s51 offen sc1
Lpsk_83:
v_cmp_eq_u32 vcc, -1, v83
s_nop 1
s_cbranch_vccz Lpsk_84
buffer_load_dwordx4 v[76:79], v20, s[4:7], s52 offen sc1
Lpsk_84:
s_branch Lpoll_78
Lpbud_80:
s_mov_b32 s81, 0
Lpdone_79:
v_pk_add_f32 v[64:65], v[64:65], v[66:67]
v_pk_add_f32 v[68:69], v[68:69], v[70:71]
v_pk_add_f32 v[72:73], v[72:73], v[74:75]
v_pk_add_f32 v[76:77], v[76:77], v[78:79]
v_pk_add_f32 v[64:65], v[64:65], v[68:69]
v_pk_add_f32 v[72:73], v[72:73], v[76:77]
v_pk_add_f32 v[30:31], v[30:31], v[64:65]
v_pk_add_f32 v[30:31], v[30:31], v[72:73]
v_cvt_pk_bf16_f32 v98, v30, v31
v_add_f32 v96, v30, v31
v_mul_f32 v97, v30, v30
ds_write_b32 v3, v98 offset:1024
v_fmac_f32 v97, v31, v31
ds_write_b64 v5, v[30:31] offset:3072
v_add_f32_dpp v96, v96, v96 row_shr:1 row_mask:0xf bank_mask:0xf
v_add_f32_dpp v97, v97, v97 row_shr:1 row_mask:0xf bank_mask:0xf
s_nop 0
v_add_f32_dpp v96, v96, v96 row_shr:2 row_mask:0xf bank_mask:0xf
v_add_f32_dpp v97, v97, v97 row_shr:2 row_mask:0xf bank_mask:0xf
s_nop 0
v_add_f32_dpp v96, v96, v96 row_shr:4 row_mask:0xf bank_mask:0xf
v_add_f32_dpp v97, v97, v97 row_shr:4 row_mask:0xf bank_mask:0xf
s_nop 0
v_add_f32_dpp v96, v96, v96 row_shr:8 row_mask:0xf bank_mask:0xf
v_add_f32_dpp v97, v97, v97 row_shr:8 row_mask:0xf bank_mask:0xf
s_nop 0
v_add_f32_dpp v96, v96, v96 row_bcast:15 row_mask:0xa bank_mask:0xf
v_add_f32_dpp v97, v97, v97 row_bcast:15 row_mask:0xa bank_mask:0xf
s_nop 0
v_add_f32_dpp v96, v96, v96 row_bcast:31 row_mask:0xc bank_mask:0xf
v_add_f32_dpp v97, v97, v97 row_bcast:31 row_mask:0xc bank_mask:0xf
s_mov_b32 exec_lo, 0
s_mov_b32 exec_hi, 0x80000000
ds_write_b64 v21, v[96:97] offset:5120
s_mov_b64 exec, -1
s_waitcnt lgkmcnt(0)
s_barrier
ds_read_b128 v[128:131], v23 offset:5120
ds_read_b128 v[60:63], v23 offset:5136
ds_read_b128 v[64:67], v11 offset:0
ds_read_b128 v[68:71], v11 offset:128
ds_read_b128 v[72:75], v11 offset:256
ds_read_b128 v[76:79], v11 offset:384
ds_read_b128 v[80:83], v11 offset:512
ds_read_b128 v[84:87], v11 offset:640
ds_read_b128 v[88:91], v11 offset:768
ds_read_b128 v[92:95], v11 offset:896
s_waitcnt lgkmcnt(8)
v_mov_b32 v99, s66
s_waitcnt lgkmcnt(7)
v_smfmac_f32_16x16x64_bf16 v[56:59], v[64:67], v[192:199], v13
v_add_f32 v128, v128, v130
s_waitcnt lgkmcnt(6)
v_smfmac_f32_16x16x64_bf16 v[56:59], v[68:71], v[200:207], v13
v_add_f32 v129, v129, v131
s_waitcnt lgkmcnt(5)
v_smfmac_f32_16x16x64_bf16 v[56:59], v[72:75], v[208:215], v13
v_add_f32 v60, v60, v62
s_waitcnt lgkmcnt(4)
v_smfmac_f32_16x16x64_bf16 v[56:59], v[76:79], v[216:223], v13
v_add_f32 v61, v61, v63
s_waitcnt lgkmcnt(3)
v_smfmac_f32_16x16x64_bf16 v[56:59], v[80:83], v[224:231], v13
v_add_f32 v128, v128, v60
s_waitcnt lgkmcnt(2)
v_smfmac_f32_16x16x64_bf16 v[56:59], v[84:87], v[232:239], v13
v_add_f32 v129, v129, v61
s_waitcnt lgkmcnt(1)
v_smfmac_f32_16x16x64_bf16 v[56:59], v[88:91], v[240:247], v13
v_mul_f32 v132, 0x3b000000, v128
s_waitcnt lgkmcnt(0)
v_smfmac_f32_16x16x64_bf16 v[56:59], v[92:95], v[248:255], v13
v_mul_f32 v129, 0x3b000000, v129
v_fma_f32 v129, -v132, v132, v129
v_add_f32 v129, 0x3727c5ac, v129
v_max_f32 v129, 0x3727c5ac, v129
v_rsq_f32 v133, v129
s_nop 2
v_add_f32 v64, v56, v57
v_add_f32 v66, v58, v59
v_fma_f32 v64, -v132, v66, v64
v_fma_f32 v64, v64, v133, v22
v_mul_f32 v65, v64, v64
v_fma_f32 v65, v65, s67, v99
v_mul_f32 v65, v65, v64
v_exp_f32 v65, v65
s_nop 0
v_add_f32 v65, 1.0, v65
v_rcp_f32 v65, v65
s_nop 0
v_mul_f32 v64, v64, v65
s_nop 1
v_mov_b32_dpp v65, v64 quad_perm:[1,1,3,3] row_mask:0xf bank_mask:0xf
v_cvt_pk_bf16_f32 v64, v64, v65
s_mov_b64 exec, s[60:61]
buffer_store_dword v64, v15, s[4:7], s53 offen
s_mov_b32 exec_lo, 0xffffffff
s_mov_b32 exec_hi, 0xffffff
v_mov_b64 v[128:129], 0
s_nop 1
Lpoll_85:
buffer_load_dwordx4 v[64:67], v37, s[4:7], s54 offen sc1
s_waitcnt vmcnt(0)
v_max3_u32 v68, v64, v65, v66
v_max_u32 v68, v68, v67
v_cmp_eq_u32 vcc, -1, v68
s_nop 1
s_cbranch_vccz Lpdone_86
s_sub_u32 s81, s81, 1
s_cbranch_scc0 Lpoll_85
s_mov_b32 s81, 0
Lpdone_86:
ds_write_b128 v33, v[64:67]
s_mov_b64 exec, -1
ds_read_b128 v[64:67], v14 offset:0
ds_read_b128 v[68:71], v14 offset:128
ds_read_b128 v[72:75], v14 offset:256
ds_read_b128 v[76:79], v14 offset:384
ds_read_b128 v[80:83], v14 offset:512
ds_read_b128 v[84:87], v14 offset:640
ds_read_b128 v[88:91], v14 offset:768
s_waitcnt lgkmcnt(6)
v_smfmac_f32_16x16x64_bf16 v[128:131], v[64:67], v[136:143], v13
s_waitcnt lgkmcnt(5)
v_smfmac_f32_16x16x64_bf16 v[128:131], v[68:71], v[144:151], v13
s_waitcnt lgkmcnt(4)
v_smfmac_f32_16x16x64_bf16 v[128:131], v[72:75], v[152:159], v13
s_waitcnt lgkmcnt(3)
v_smfmac_f32_16x16x64_bf16 v[128:131], v[76:79], v[160:167], v13
s_waitcnt lgkmcnt(2)
v_smfmac_f32_16x16x64_bf16 v[128:131], v[80:83], v[168:175], v13
s_waitcnt lgkmcnt(1)
v_smfmac_f32_16x16x64_bf16 v[128:131], v[84:87], v[176:183], v13
s_waitcnt lgkmcnt(0)
v_smfmac_f32_16x16x64_bf16 v[128:131], v[88:91], v[184:191], v13
s_mov_b32 exec_lo, 0xffff
s_mov_b32 exec_hi, 0
s_nop 5
v_add_f32 v128, v128, v129
ds_write_b32 v35, v128
s_mov_b64 exec, -1
ds_read_b32 v68, v24
s_waitcnt lgkmcnt(0)
v_add_f32 v68, v68, v26
s_barrier
ds_read_b32 v64, v36 offset:0
ds_read_b32 v65, v36 offset:64
ds_read_b32 v66, v36 offset:128
ds_read_b32 v67, v36 offset:192
s_waitcnt lgkmcnt(0)
v_add_f32 v64, v64, v65
v_add_f32 v66, v66, v67
v_add_f32 v64, v64, v68
v_add_f32 v64, v64, v66
s_cmp_eq_u32 s85, 1
s_mov_b64 exec, s[62:63]
s_cbranch_scc1 Lout_87
buffer_store_dword v64, v39, s[4:7], s55 offen
s_mov_b64 exec, -1
v_mov_b64 v[52:53], 0
v_mov_b64 v[54:55], 0
v_mov_b64 v[56:57], 0
v_mov_b64 v[58:59], 0
s_nop 1
Lpoll_89:
buffer_load_dwordx2 v[30:31], v4, s[4:7], s56 offen sc1
s_waitcnt vmcnt(0)
v_max_u32 v64, v30, v31
v_cmp_eq_u32 vcc, -1, v64
s_nop 1
s_cbranch_vccz Lpdone_90
s_sub_u32 s81, s81, 1
s_cbranch_scc0 Lpoll_89
s_mov_b32 s81, 0
Lpdone_90:
v_cvt_pk_bf16_f32 v98, v30, v31
v_add_f32 v96, v30, v31
v_mul_f32 v97, v30, v30
ds_write_b32 v3, v98 offset:2048
v_fmac_f32 v97, v31, v31
v_add_f32_dpp v96, v96, v96 row_shr:1 row_mask:0xf bank_mask:0xf
s_nop 0
v_add_f32_dpp v97, v97, v97 row_shr:1 row_mask:0xf bank_mask:0xf
v_add_f32_dpp v96, v96, v96 row_shr:2 row_mask:0xf bank_mask:0xf
s_nop 0
v_add_f32_dpp v97, v97, v97 row_shr:2 row_mask:0xf bank_mask:0xf
v_add_f32_dpp v96, v96, v96 row_shr:4 row_mask:0xf bank_mask:0xf
s_nop 0
v_add_f32_dpp v97, v97, v97 row_shr:4 row_mask:0xf bank_mask:0xf
v_add_f32_dpp v96, v96, v96 row_shr:8 row_mask:0xf bank_mask:0xf
s_nop 0
v_add_f32_dpp v97, v97, v97 row_shr:8 row_mask:0xf bank_mask:0xf
v_add_f32_dpp v96, v96, v96 row_bcast:15 row_mask:0xa bank_mask:0xf
s_nop 0
v_add_f32_dpp v97, v97, v97 row_bcast:15 row_mask:0xa bank_mask:0xf
v_add_f32_dpp v96, v96, v96 row_bcast:31 row_mask:0xc bank_mask:0xf
s_nop 0
v_add_f32_dpp v97, v97, v97 row_bcast:31 row_mask:0xc bank_mask:0xf
s_mov_b32 exec_lo, 0
s_mov_b32 exec_hi, 0x80000000
ds_write_b64 v21, v[96:97] offset:5152
s_mov_b64 exec, -1
s_waitcnt lgkmcnt(0)
s_barrier
ds_read_b128 v[128:131], v23 offset:5152
ds_read_b128 v[60:63], v23 offset:5168
ds_read_b128 v[64:67], v12 offset:0
ds_read_b128 v[68:71], v12 offset:128
ds_read_b128 v[72:75], v12 offset:256
ds_read_b128 v[76:79], v12 offset:384
ds_read_b128 v[80:83], v12 offset:512
ds_read_b128 v[84:87], v12 offset:640
ds_read_b128 v[88:91], v12 offset:768
ds_read_b128 v[92:95], v12 offset:896
s_waitcnt lgkmcnt(8)
s_waitcnt lgkmcnt(7)
v_smfmac_f32_16x16x64_bf16 v[52:55], v[64:67], a[0:7], v13
v_add_f32 v128, v128, v130
v_smfmac_f32_16x16x64_bf16 v[56:59], v[64:67], a[64:71], v13
v_add_f32 v129, v129, v131
s_waitcnt lgkmcnt(6)
v_smfmac_f32_16x16x64_bf16 v[52:55], v[68:71], a[8:15], v13
v_add_f32 v60, v60, v62
v_smfmac_f32_16x16x64_bf16 v[56:59], v[68:71], a[72:79], v13
v_add_f32 v61, v61, v63
s_waitcnt lgkmcnt(5)
v_smfmac_f32_16x16x64_bf16 v[52:55], v[72:75], a[16:23], v13
v_add_f32 v128, v128, v60
v_smfmac_f32_16x16x64_bf16 v[56:59], v[72:75], a[80:87], v13
v_add_f32 v129, v129, v61
s_waitcnt lgkmcnt(4)
v_smfmac_f32_16x16x64_bf16 v[52:55], v[76:79], a[24:31], v13
v_mul_f32 v132, 0x3b000000, v128
v_smfmac_f32_16x16x64_bf16 v[56:59], v[76:79], a[88:95], v13
v_mul_f32 v129, 0x3b000000, v129
s_waitcnt lgkmcnt(3)
v_smfmac_f32_16x16x64_bf16 v[52:55], v[80:83], a[32:39], v13
v_fma_f32 v129, -v132, v132, v129
v_smfmac_f32_16x16x64_bf16 v[56:59], v[80:83], a[96:103], v13
v_add_f32 v129, 0x3727c5ac, v129
s_waitcnt lgkmcnt(2)
v_smfmac_f32_16x16x64_bf16 v[52:55], v[84:87], a[40:47], v13
v_max_f32 v129, 0x3727c5ac, v129
v_smfmac_f32_16x16x64_bf16 v[56:59], v[84:87], a[104:111], v13
v_rsq_f32 v133, v129
s_waitcnt lgkmcnt(1)
v_smfmac_f32_16x16x64_bf16 v[52:55], v[88:91], a[48:55], v13
v_mul_f32 v133, 0x3e0293ee, v133
v_smfmac_f32_16x16x64_bf16 v[56:59], v[88:91], a[112:119], v13
v_add_u32 v100, s58, v16
s_waitcnt lgkmcnt(0)
v_smfmac_f32_16x16x64_bf16 v[52:55], v[92:95], a[56:63], v13
v_smfmac_f32_16x16x64_bf16 v[56:59], v[92:95], a[120:127], v13
s_nop 6
v_add_f32_dpp v96, v52, v53 quad_perm:[0,1,2,3] row_mask:0x1 bank_mask:0xf
v_add_f32_dpp v97, v54, v55 quad_perm:[0,1,2,3] row_mask:0x1 bank_mask:0xf
v_add_f32_dpp v96, v56, v57 quad_perm:[0,1,2,3] row_mask:0x2 bank_mask:0xf
v_add_f32_dpp v97, v58, v59 quad_perm:[0,1,2,3] row_mask:0x2 bank_mask:0xf
v_fma_f32 v96, -v132, v97, v96
v_mul_f32 v96, v96, v133
s_nop 1
v_mov_b32_dpp v98, v96 quad_perm:[1,1,3,3] row_mask:0xf bank_mask:0xf
s_mov_b32 exec_lo, 0x55555555
s_mov_b32 exec_hi, 0
v_cvt_pk_bf16_f32 v96, v96, v98
buffer_store_dword v96, v17, s[4:7], s57 offen offset:0 sc1
ds_write_b32 v100, v96
s_mov_b64 exec, -1
s_cmp_eq_u32 s84, 0
s_cbranch_scc0 Lsx_91
v_mov_b32 v6, v30
v_mov_b32 v7, v31
s_nop 1
s_branch Lsxe_92
Lsx_91:
v_mov_b32 v8, v30
v_mov_b32 v9, v31
s_nop 1
Lsxe_92:
s_waitcnt lgkmcnt(0)
s_barrier
s_lshl_b32 s87, s84, 8
v_add_u32 v96, s87, v2
ds_read_b128 v[52:55], v96 offset:5440
ds_read_b128 v[56:59], v96 offset:5504
ds_read_b128 v[60:63], v96 offset:5568
ds_read_b128 v[64:67], v96 offset:5632
s_xor_b32 s88, s84, 1
s_lshl_b32 s88, s88, 14
s_add_u32 s88, s88, s89
v_and_b32 v82, 15, v1
v_and_b32 v83, 7, v1
v_lshlrev_b32 v83, 1, v83
v_lshrrev_b32 v41, 4, v1
v_xor_b32 v83, v83, v41
v_lshlrev_b32 v83, 4, v83
v_lshlrev_b32 v82, 8, v82
v_add_u32 v82, v82, v83
v_add_u32 v40, s88, v82
v_xor_b32 v41, 64, v40
v_xor_b32 v42, 128, v40
v_xor_b32 v43, 192, v40
v_lshrrev_b32 v82, 2, v1
v_and_b32 v83, 7, v82
v_lshlrev_b32 v83, 1, v83
v_lshlrev_b32 v82, 8, v82
v_bfe_u32 v45, v1, 1, 1
v_xor_b32 v83, v83, v45
v_lshlrev_b32 v83, 4, v83
v_add_u32 v82, v82, v83
v_and_b32 v83, 1, v1
v_lshlrev_b32 v83, 3, v83
v_add_u32 v82, v82, v83
v_add_u32 v44, s88, v82
v_xor_b32 v45, 32, v44
v_xor_b32 v46, 64, v44
v_xor_b32 v47, 96, v44
v_xor_b32 v48, 128, v44
v_xor_b32 v49, 160, v44
v_xor_b32 v50, 192, v44
v_xor_b32 v51, 224, v44
v_mov_b32 v80, 0xff800000
v_mov_b32 v81, 0
v_mov_b32 v76, 0
v_mov_b32 v77, 0
v_mov_b32 v78, 0
v_mov_b32 v79, 0
s_waitcnt lgkmcnt(0)
ds_read_b128 v[96:99], v40 offset:0
ds_read_b128 v[100:103], v41 offset:0
ds_read_b128 v[104:107], v42 offset:0
ds_read_b128 v[108:111], v43 offset:0
ds_read_b128 v[112:115], v40 offset:4096
ds_read_b128 v[116:119], v41 offset:4096
ds_read_b128 v[120:123], v42 offset:4096
ds_read_b128 v[124:127], v43 offset:4096
s_waitcnt lgkmcnt(7)
v_mfma_f32_16x16x32_bf16 v[68:71], v[96:99], v[52:55], 0
s_waitcnt lgkmcnt(6)
v_mfma_f32_16x16x32_bf16 v[68:71], v[100:103], v[56:59], v[68:71]
s_waitcnt lgkmcnt(5)
v_mfma_f32_16x16x32_bf16 v[68:71], v[104:107], v[60:63], v[68:71]
s_waitcnt lgkmcnt(4)
v_mfma_f32_16x16x32_bf16 v[68:71], v[108:111], v[64:67], v[68:71]
s_waitcnt lgkmcnt(3)
v_mfma_f32_16x16x32_bf16 v[72:75], v[112:115], v[52:55], 0
s_waitcnt lgkmcnt(2)
v_mfma_f32_16x16x32_bf16 v[72:75], v[116:119], v[56:59], v[72:75]
s_waitcnt lgkmcnt(1)
v_mfma_f32_16x16x32_bf16 v[72:75], v[120:123], v[60:63], v[72:75]
s_waitcnt lgkmcnt(0)
v_mfma_f32_16x16x32_bf16 v[72:75], v[124:127], v[64:67], v[72:75]
ds_read_b64_tr_b16 v[96:97], v44 offset:8192
ds_read_b64_tr_b16 v[98:99], v44 offset:12288
ds_read_b64_tr_b16 v[100:101], v45 offset:8192
ds_read_b64_tr_b16 v[102:103], v45 offset:12288
ds_read_b64_tr_b16 v[104:105], v46 offset:8192
ds_read_b64_tr_b16 v[106:107], v46 offset:12288
ds_read_b64_tr_b16 v[108:109], v47 offset:8192
ds_read_b64_tr_b16 v[110:111], v47 offset:12288
ds_read_b64_tr_b16 v[112:113], v48 offset:8192
ds_read_b64_tr_b16 v[114:115], v48 offset:12288
ds_read_b64_tr_b16 v[116:117], v49 offset:8192
ds_read_b64_tr_b16 v[118:119], v49 offset:12288
ds_read_b64_tr_b16 v[120:121], v50 offset:8192
ds_read_b64_tr_b16 v[122:123], v50 offset:12288
ds_read_b64_tr_b16 v[124:125], v51 offset:8192
ds_read_b64_tr_b16 v[126:127], v51 offset:12288
v_max3_f32 v82, v68, v69, v70
v_max3_f32 v83, v72, v73, v74
v_max3_f32 v82, v82, v71, v75
v_max3_f32 v82, v82, v83, v80
v_mov_b32 v83, v82
s_nop 1
v_permlane16_swap_b32 v82, v83
v_max_f32 v82, v82, v83
v_mov_b32 v83, v82
s_nop 1
v_permlane32_swap_b32 v82, v83
v_max_f32 v82, v82, v83
v_sub_f32 v83, v80, v82
v_exp_f32 v83, v83
v_mov_b32 v80, v82
v_sub_f32 v68, v68, v82
v_sub_f32 v69, v69, v82
v_sub_f32 v70, v70, v82
v_sub_f32 v71, v71, v82
v_sub_f32 v72, v72, v82
v_sub_f32 v73, v73, v82
v_sub_f32 v74, v74, v82
v_sub_f32 v75, v75, v82
v_exp_f32 v68, v68
v_exp_f32 v69, v69
v_exp_f32 v70, v70
v_exp_f32 v71, v71
v_exp_f32 v72, v72
v_exp_f32 v73, v73
v_exp_f32 v74, v74
v_exp_f32 v75, v75
v_mul_f32 v81, v81, v83
v_mul_f32 v76, v76, v83
v_mul_f32 v77, v77, v83
v_mul_f32 v78, v78, v83
v_mul_f32 v79, v79, v83
v_add_f32 v84, v68, v69
v_add_f32 v85, v70, v71
v_add_f32 v84, v84, v72
v_add_f32 v85, v85, v73
v_add_f32 v84, v84, v74
v_add_f32 v85, v85, v75
v_add_f32 v81, v81, v84
v_add_f32 v81, v81, v85
v_cvt_pk_bf16_f32 v68, v68, v69
v_cvt_pk_bf16_f32 v69, v70, v71
v_cvt_pk_bf16_f32 v70, v72, v73
v_cvt_pk_bf16_f32 v71, v74, v75
v_cndmask_b32_e64 v88, 0, v68, s[16:17]
v_cndmask_b32_e64 v89, 0, v69, s[16:17]
v_cndmask_b32_e64 v90, 0, v70, s[16:17]
v_cndmask_b32_e64 v91, 0, v71, s[16:17]
v_cndmask_b32_e64 v92, 0, v68, s[18:19]
v_cndmask_b32_e64 v93, 0, v69, s[18:19]
v_cndmask_b32_e64 v94, 0, v70, s[18:19]
v_cndmask_b32_e64 v95, 0, v71, s[18:19]
s_waitcnt lgkmcnt(14)
v_mfma_f32_16x16x32_bf16 v[76:79], v[96:99], v[88:91], v[76:79]
v_cndmask_b32_e64 v88, 0, v68, s[20:21]
v_cndmask_b32_e64 v89, 0, v69, s[20:21]
v_cndmask_b32_e64 v90, 0, v70, s[20:21]
v_cndmask_b32_e64 v91, 0, v71, s[20:21]
s_waitcnt lgkmcnt(12)
v_mfma_f32_16x16x32_bf16 v[76:79], v[100:103], v[92:95], v[76:79]
v_cndmask_b32_e64 v92, 0, v68, s[22:23]
v_cndmask_b32_e64 v93, 0, v69, s[22:23]
v_cndmask_b32_e64 v94, 0, v70, s[22:23]
v_cndmask_b32_e64 v95, 0, v71, s[22:23]
s_waitcnt lgkmcnt(10)
v_mfma_f32_16x16x32_bf16 v[76:79], v[104:107], v[88:91], v[76:79]
v_cndmask_b32_e64 v88, 0, v68, s[24:25]
v_cndmask_b32_e64 v89, 0, v69, s[24:25]
v_cndmask_b32_e64 v90, 0, v70, s[24:25]
v_cndmask_b32_e64 v91, 0, v71, s[24:25]
s_waitcnt lgkmcnt(8)
v_mfma_f32_16x16x32_bf16 v[76:79], v[108:111], v[92:95], v[76:79]
v_cndmask_b32_e64 v92, 0, v68, s[26:27]
v_cndmask_b32_e64 v93, 0, v69, s[26:27]
v_cndmask_b32_e64 v94, 0, v70, s[26:27]
v_cndmask_b32_e64 v95, 0, v71, s[26:27]
s_waitcnt lgkmcnt(6)
v_mfma_f32_16x16x32_bf16 v[76:79], v[112:115], v[88:91], v[76:79]
v_cndmask_b32_e64 v88, 0, v68, s[28:29]
v_cndmask_b32_e64 v89, 0, v69, s[28:29]
v_cndmask_b32_e64 v90, 0, v70, s[28:29]
v_cndmask_b32_e64 v91, 0, v71, s[28:29]
s_waitcnt lgkmcnt(4)
v_mfma_f32_16x16x32_bf16 v[76:79], v[116:119], v[92:95], v[76:79]
v_cndmask_b32_e64 v92, 0, v68, s[30:31]
v_cndmask_b32_e64 v93, 0, v69, s[30:31]
v_cndmask_b32_e64 v94, 0, v70, s[30:31]
v_cndmask_b32_e64 v95, 0, v71, s[30:31]
s_waitcnt lgkmcnt(2)
v_mfma_f32_16x16x32_bf16 v[76:79], v[120:123], v[88:91], v[76:79]
s_waitcnt lgkmcnt(0)
v_mfma_f32_16x16x32_bf16 v[76:79], v[124:127], v[92:95], v[76:79]
s_mul_i32 s87, s3, 544
s_add_u32 s87, s87, 157696
v_mov_b32 v83, v81
s_nop 1
v_permlane16_swap_b32 v81, v83
v_add_f32 v81, v81, v83
v_mov_b32 v83, v81
s_nop 1
v_permlane32_swap_b32 v81, v83
v_add_f32 v81, v81, v83
v_and_b32 v96, 15, v1
v_lshlrev_b32 v96, 6, v96
v_lshrrev_b32 v97, 4, v1
v_lshlrev_b32 v97, 4, v97
v_add_u32 v96, v96, v97
v_add_u32 v96, s87, v96
v_mov_b32 v97, s87
s_mov_b32 exec_lo, 0xff00ff
s_mov_b32 exec_hi, 0xff00ff
ds_write_b128 v96, v[76:79]
s_mov_b32 exec_lo, 0x1
s_mov_b32 exec_hi, 0x0
ds_write_b64 v97, v[80:81] offset:512
s_mov_b64 exec, -1
s_waitcnt lgkmcnt(0)
s_barrier
s_cmp_lg_u32 s3, 0
s_cbranch_scc1 Lnp_93
s_lshl_b32 s88, s80, 3
s_add_u32 s88, s88, 7
s_mul_i32 s88, s88, 640
s_add_u32 s88, s88, s94
s_add_u32 s88, s88, 8192
s_mov_b32 s87, 157696
v_and_b32 v125, 31, v1
v_lshlrev_b32 v125, 4, v125
v_add_u32 v125, s87, v125
v_mov_b32 v126, s87
ds_read_b64 v[112:113], v126 offset:512
ds_read_b64 v[114:115], v126 offset:1056
ds_read_b64 v[116:117], v126 offset:1600
ds_read_b64 v[118:119], v126 offset:2144
ds_read_b128 v[96:99], v125 offset:0
ds_read_b128 v[100:103], v125 offset:544
ds_read_b128 v[104:107], v125 offset:1088
ds_read_b128 v[108:111], v125 offset:1632
s_waitcnt lgkmcnt(4)
v_max3_f32 v120, v112, v114, v116
v_max_f32 v120, v120, v118
v_sub_f32 v121, v112, v120
v_sub_f32 v122, v114, v120
v_sub_f32 v123, v116, v120
v_sub_f32 v124, v118, v120
v_exp_f32 v121, v121
v_exp_f32 v122, v122
v_exp_f32 v123, v123
v_exp_f32 v124, v124
v_mul_f32 v127, v121, v113
v_fmac_f32 v127, v122, v115
v_fmac_f32 v127, v123, v117
v_fmac_f32 v127, v124, v119
s_waitcnt lgkmcnt(0)
v_mul_f32 v96, v121, v96
v_mul_f32 v97, v121, v97
v_mul_f32 v98, v121, v98
v_mul_f32 v99, v121, v99
v_fmac_f32 v96, v122, v100
v_fmac_f32 v97, v122, v101
v_fmac_f32 v98, v122, v102
v_fmac_f32 v99, v122, v103
v_fmac_f32 v96, v123, v104
v_fmac_f32 v97, v123, v105
v_fmac_f32 v98, v123, v106
v_fmac_f32 v99, v123, v107
v_fmac_f32 v96, v124, v108
v_fmac_f32 v97, v124, v109
v_fmac_f32 v98, v124, v110
v_fmac_f32 v99, v124, v111
s_mov_b32 s32, 0
s_mov_b32 s33, 1
v_cndmask_b32_e64 v96, v96, v120, s[32:33]
v_cndmask_b32_e64 v97, v97, v127, s[32:33]
v_cndmask_b32_e64 v98, v98, 0, s[32:33]
v_cndmask_b32_e64 v99, v99, 0, s[32:33]
v_lshlrev_b32 v125, 4, v1
s_mov_b32 exec_lo, 0xffffffff
s_mov_b32 exec_hi, 0x1
buffer_store_dwordx4 v[96:99], v125, s[4:7], s88 offen sc1
s_mov_b64 exec, -1
s_nop 0
Lnp_93:
s_branch Lnext_88
Lout_87:
v_cvt_pk_bf16_f32 v64, v64, v64
buffer_store_short v64, v25, s[76:79], s68 offen
s_mov_b64 exec, -1
Lnext_88:
s_cmp_lg_u32 s82, 0
s_cbranch_scc1 Ldk_94
v_lshrrev_b32 v99, 4, v1
v_lshlrev_b32 v100, 1, v99
v_and_b32 v86, 15, v1
v_xor_b32 v86, v86, v100
v_lshlrev_b32 v86, 4, v86
v_lshlrev_b32 v99, 8, v99
v_add_u32 v86, v86, v99
v_xor_b32 v87, 0x80, v86
s_add_u32 s87, s3, 252
s_lshl_b32 s87, s87, 13
s_lshl_b32 s88, s80, 21
s_add_u32 s87, s87, s88
s_add_u32 s92, s87, 0
s_add_u32 s93, s89, 16384
s_mov_b32 m0, s93
s_nop 0
buffer_load_dwordx4 v86, s[8:11], s92 offen offset:0 nt lds
buffer_load_dwordx4 v87, s[8:11], s92 offen offset:1024 nt lds
buffer_load_dwordx4 v86, s[8:11], s92 offen offset:2048 nt lds
buffer_load_dwordx4 v87, s[8:11], s92 offen offset:3072 nt lds
s_add_u32 s92, s87, 4096
s_add_u32 s93, s89, 20480
s_mov_b32 m0, s93
s_nop 0
buffer_load_dwordx4 v86, s[8:11], s92 offen offset:0 nt lds
buffer_load_dwordx4 v87, s[8:11], s92 offen offset:1024 nt lds
buffer_load_dwordx4 v86, s[8:11], s92 offen offset:2048 nt lds
buffer_load_dwordx4 v87, s[8:11], s92 offen offset:3072 nt lds
s_add_u32 s92, s87, 0
s_add_u32 s93, s89, 24576
s_mov_b32 m0, s93
s_nop 0
buffer_load_dwordx4 v86, s[12:15], s92 offen offset:0 nt lds
buffer_load_dwordx4 v87, s[12:15], s92 offen offset:1024 nt lds
buffer_load_dwordx4 v86, s[12:15], s92 offen offset:2048 nt lds
buffer_load_dwordx4 v87, s[12:15], s92 offen offset:3072 nt lds
s_add_u32 s92, s87, 4096
s_add_u32 s93, s89, 28672
s_mov_b32 m0, s93
s_nop 0
buffer_load_dwordx4 v86, s[12:15], s92 offen offset:0 nt lds
buffer_load_dwordx4 v87, s[12:15], s92 offen offset:1024 nt lds
buffer_load_dwordx4 v86, s[12:15], s92 offen offset:2048 nt lds
buffer_load_dwordx4 v87, s[12:15], s92 offen offset:3072 nt lds
Ldk_94:
s_cmp_lg_u32 s82, 1
s_cbranch_scc1 Ldk_95
s_mov_b32 s84, 0
s_mov_b32 s94, 0
s_waitcnt vmcnt(0)
s_waitcnt lgkmcnt(0)
s_barrier
s_lshl_b32 s87, s84, 8
v_add_u32 v96, s87, v2
ds_read_b128 v[52:55], v96 offset:5440
ds_read_b128 v[56:59], v96 offset:5504
ds_read_b128 v[60:63], v96 offset:5568
ds_read_b128 v[64:67], v96 offset:5632
s_xor_b32 s88, s84, 1
s_lshl_b32 s88, s88, 14
s_add_u32 s88, s88, s89
v_and_b32 v82, 15, v1
v_and_b32 v83, 7, v1
v_lshlrev_b32 v83, 1, v83
v_lshrrev_b32 v41, 4, v1
v_xor_b32 v83, v83, v41
v_lshlrev_b32 v83, 4, v83
v_lshlrev_b32 v82, 8, v82
v_add_u32 v82, v82, v83
v_add_u32 v40, s88, v82
v_xor_b32 v41, 64, v40
v_xor_b32 v42, 128, v40
v_xor_b32 v43, 192, v40
v_lshrrev_b32 v82, 2, v1
v_and_b32 v83, 7, v82
v_lshlrev_b32 v83, 1, v83
v_lshlrev_b32 v82, 8, v82
v_bfe_u32 v45, v1, 1, 1
v_xor_b32 v83, v83, v45
v_lshlrev_b32 v83, 4, v83
v_add_u32 v82, v82, v83
v_and_b32 v83, 1, v1
v_lshlrev_b32 v83, 3, v83
v_add_u32 v82, v82, v83
v_add_u32 v44, s88, v82
v_xor_b32 v45, 32, v44
v_xor_b32 v46, 64, v44
v_xor_b32 v47, 96, v44
v_xor_b32 v48, 128, v44
v_xor_b32 v49, 160, v44
v_xor_b32 v50, 192, v44
v_xor_b32 v51, 224, v44
v_mov_b32 v80, 0xff800000
v_mov_b32 v81, 0
v_mov_b32 v76, 0
v_mov_b32 v77, 0
v_mov_b32 v78, 0
v_mov_b32 v79, 0
s_waitcnt lgkmcnt(0)
ds_read_b128 v[96:99], v40 offset:0
ds_read_b128 v[100:103], v41 offset:0
ds_read_b128 v[104:107], v42 offset:0
ds_read_b128 v[108:111], v43 offset:0
ds_read_b128 v[112:115], v40 offset:4096
ds_read_b128 v[116:119], v41 offset:4096
ds_read_b128 v[120:123], v42 offset:4096
ds_read_b128 v[124:127], v43 offset:4096
s_waitcnt lgkmcnt(7)
v_mfma_f32_16x16x32_bf16 v[68:71], v[96:99], v[52:55], 0
s_waitcnt lgkmcnt(6)
v_mfma_f32_16x16x32_bf16 v[68:71], v[100:103], v[56:59], v[68:71]
s_waitcnt lgkmcnt(5)
v_mfma_f32_16x16x32_bf16 v[68:71], v[104:107], v[60:63], v[68:71]
s_waitcnt lgkmcnt(4)
v_mfma_f32_16x16x32_bf16 v[68:71], v[108:111], v[64:67], v[68:71]
s_waitcnt lgkmcnt(3)
v_mfma_f32_16x16x32_bf16 v[72:75], v[112:115], v[52:55], 0
s_waitcnt lgkmcnt(2)
v_mfma_f32_16x16x32_bf16 v[72:75], v[116:119], v[56:59], v[72:75]
s_waitcnt lgkmcnt(1)
v_mfma_f32_16x16x32_bf16 v[72:75], v[120:123], v[60:63], v[72:75]
s_waitcnt lgkmcnt(0)
v_mfma_f32_16x16x32_bf16 v[72:75], v[124:127], v[64:67], v[72:75]
ds_read_b64_tr_b16 v[96:97], v44 offset:8192
ds_read_b64_tr_b16 v[98:99], v44 offset:12288
ds_read_b64_tr_b16 v[100:101], v45 offset:8192
ds_read_b64_tr_b16 v[102:103], v45 offset:12288
ds_read_b64_tr_b16 v[104:105], v46 offset:8192
ds_read_b64_tr_b16 v[106:107], v46 offset:12288
ds_read_b64_tr_b16 v[108:109], v47 offset:8192
ds_read_b64_tr_b16 v[110:111], v47 offset:12288
ds_read_b64_tr_b16 v[112:113], v48 offset:8192
ds_read_b64_tr_b16 v[114:115], v48 offset:12288
ds_read_b64_tr_b16 v[116:117], v49 offset:8192
ds_read_b64_tr_b16 v[118:119], v49 offset:12288
ds_read_b64_tr_b16 v[120:121], v50 offset:8192
ds_read_b64_tr_b16 v[122:123], v50 offset:12288
ds_read_b64_tr_b16 v[124:125], v51 offset:8192
ds_read_b64_tr_b16 v[126:127], v51 offset:12288
v_max3_f32 v82, v68, v69, v70
v_max3_f32 v83, v72, v73, v74
v_max3_f32 v82, v82, v71, v75
v_max3_f32 v82, v82, v83, v80
v_mov_b32 v83, v82
s_nop 1
v_permlane16_swap_b32 v82, v83
v_max_f32 v82, v82, v83
v_mov_b32 v83, v82
s_nop 1
v_permlane32_swap_b32 v82, v83
v_max_f32 v82, v82, v83
v_sub_f32 v83, v80, v82
v_exp_f32 v83, v83
v_mov_b32 v80, v82
v_sub_f32 v68, v68, v82
v_sub_f32 v69, v69, v82
v_sub_f32 v70, v70, v82
v_sub_f32 v71, v71, v82
v_sub_f32 v72, v72, v82
v_sub_f32 v73, v73, v82
v_sub_f32 v74, v74, v82
v_sub_f32 v75, v75, v82
v_exp_f32 v68, v68
v_exp_f32 v69, v69
v_exp_f32 v70, v70
v_exp_f32 v71, v71
v_exp_f32 v72, v72
v_exp_f32 v73, v73
v_exp_f32 v74, v74
v_exp_f32 v75, v75
v_mul_f32 v81, v81, v83
v_mul_f32 v76, v76, v83
v_mul_f32 v77, v77, v83
v_mul_f32 v78, v78, v83
v_mul_f32 v79, v79, v83
v_add_f32 v84, v68, v69
v_add_f32 v85, v70, v71
v_add_f32 v84, v84, v72
v_add_f32 v85, v85, v73
v_add_f32 v84, v84, v74
v_add_f32 v85, v85, v75
v_add_f32 v81, v81, v84
v_add_f32 v81, v81, v85
v_cvt_pk_bf16_f32 v68, v68, v69
v_cvt_pk_bf16_f32 v69, v70, v71
v_cvt_pk_bf16_f32 v70, v72, v73
v_cvt_pk_bf16_f32 v71, v74, v75
v_cndmask_b32_e64 v88, 0, v68, s[16:17]
v_cndmask_b32_e64 v89, 0, v69, s[16:17]
v_cndmask_b32_e64 v90, 0, v70, s[16:17]
v_cndmask_b32_e64 v91, 0, v71, s[16:17]
v_cndmask_b32_e64 v92, 0, v68, s[18:19]
v_cndmask_b32_e64 v93, 0, v69, s[18:19]
v_cndmask_b32_e64 v94, 0, v70, s[18:19]
v_cndmask_b32_e64 v95, 0, v71, s[18:19]
s_waitcnt lgkmcnt(14)
v_mfma_f32_16x16x32_bf16 v[76:79], v[96:99], v[88:91], v[76:79]
v_cndmask_b32_e64 v88, 0, v68, s[20:21]
v_cndmask_b32_e64 v89, 0, v69, s[20:21]
v_cndmask_b32_e64 v90, 0, v70, s[20:21]
v_cndmask_b32_e64 v91, 0, v71, s[20:21]
s_waitcnt lgkmcnt(12)
v_mfma_f32_16x16x32_bf16 v[76:79], v[100:103], v[92:95], v[76:79]
v_cndmask_b32_e64 v92, 0, v68, s[22:23]
v_cndmask_b32_e64 v93, 0, v69, s[22:23]
v_cndmask_b32_e64 v94, 0, v70, s[22:23]
v_cndmask_b32_e64 v95, 0, v71, s[22:23]
s_waitcnt lgkmcnt(10)
v_mfma_f32_16x16x32_bf16 v[76:79], v[104:107], v[88:91], v[76:79]
v_cndmask_b32_e64 v88, 0, v68, s[24:25]
v_cndmask_b32_e64 v89, 0, v69, s[24:25]
v_cndmask_b32_e64 v90, 0, v70, s[24:25]
v_cndmask_b32_e64 v91, 0, v71, s[24:25]
s_waitcnt lgkmcnt(8)
v_mfma_f32_16x16x32_bf16 v[76:79], v[108:111], v[92:95], v[76:79]
v_cndmask_b32_e64 v92, 0, v68, s[26:27]
v_cndmask_b32_e64 v93, 0, v69, s[26:27]
v_cndmask_b32_e64 v94, 0, v70, s[26:27]
v_cndmask_b32_e64 v95, 0, v71, s[26:27]
s_waitcnt lgkmcnt(6)
v_mfma_f32_16x16x32_bf16 v[76:79], v[112:115], v[88:91], v[76:79]
v_cndmask_b32_e64 v88, 0, v68, s[28:29]
v_cndmask_b32_e64 v89, 0, v69, s[28:29]
v_cndmask_b32_e64 v90, 0, v70, s[28:29]
v_cndmask_b32_e64 v91, 0, v71, s[28:29]
s_waitcnt lgkmcnt(4)
v_mfma_f32_16x16x32_bf16 v[76:79], v[116:119], v[92:95], v[76:79]
v_cndmask_b32_e64 v92, 0, v68, s[30:31]
v_cndmask_b32_e64 v93, 0, v69, s[30:31]
v_cndmask_b32_e64 v94, 0, v70, s[30:31]
v_cndmask_b32_e64 v95, 0, v71, s[30:31]
s_waitcnt lgkmcnt(2)
v_mfma_f32_16x16x32_bf16 v[76:79], v[120:123], v[88:91], v[76:79]
s_waitcnt lgkmcnt(0)
v_mfma_f32_16x16x32_bf16 v[76:79], v[124:127], v[92:95], v[76:79]
s_mul_i32 s87, s3, 544
s_add_u32 s87, s87, 157696
v_mov_b32 v83, v81
s_nop 1
v_permlane16_swap_b32 v81, v83
v_add_f32 v81, v81, v83
v_mov_b32 v83, v81
s_nop 1
v_permlane32_swap_b32 v81, v83
v_add_f32 v81, v81, v83
v_and_b32 v96, 15, v1
v_lshlrev_b32 v96, 6, v96
v_lshrrev_b32 v97, 4, v1
v_lshlrev_b32 v97, 4, v97
v_add_u32 v96, v96, v97
v_add_u32 v96, s87, v96
v_mov_b32 v97, s87
s_mov_b32 exec_lo, 0xff00ff
s_mov_b32 exec_hi, 0xff00ff
ds_write_b128 v96, v[76:79]
s_mov_b32 exec_lo, 0x1
s_mov_b32 exec_hi, 0x0
ds_write_b64 v97, v[80:81] offset:512
s_mov_b64 exec, -1
s_waitcnt lgkmcnt(0)
s_barrier
s_cmp_lg_u32 s3, 0
s_cbranch_scc1 Lnp_96
s_lshl_b32 s88, s80, 3
s_add_u32 s88, s88, 7
s_mul_i32 s88, s88, 640
s_add_u32 s88, s88, s94
s_add_u32 s88, s88, 8192
s_mov_b32 s87, 157696
v_and_b32 v125, 31, v1
v_lshlrev_b32 v125, 4, v125
v_add_u32 v125, s87, v125
v_mov_b32 v126, s87
ds_read_b64 v[112:113], v126 offset:512
ds_read_b64 v[114:115], v126 offset:1056
ds_read_b64 v[116:117], v126 offset:1600
ds_read_b64 v[118:119], v126 offset:2144
ds_read_b128 v[96:99], v125 offset:0
ds_read_b128 v[100:103], v125 offset:544
ds_read_b128 v[104:107], v125 offset:1088
ds_read_b128 v[108:111], v125 offset:1632
s_waitcnt lgkmcnt(4)
v_max3_f32 v120, v112, v114, v116
v_max_f32 v120, v120, v118
v_sub_f32 v121, v112, v120
v_sub_f32 v122, v114, v120
v_sub_f32 v123, v116, v120
v_sub_f32 v124, v118, v120
v_exp_f32 v121, v121
v_exp_f32 v122, v122
v_exp_f32 v123, v123
v_exp_f32 v124, v124
v_mul_f32 v127, v121, v113
v_fmac_f32 v127, v122, v115
v_fmac_f32 v127, v123, v117
v_fmac_f32 v127, v124, v119
s_waitcnt lgkmcnt(0)
v_mul_f32 v96, v121, v96
v_mul_f32 v97, v121, v97
v_mul_f32 v98, v121, v98
v_mul_f32 v99, v121, v99
v_fmac_f32 v96, v122, v100
v_fmac_f32 v97, v122, v101
v_fmac_f32 v98, v122, v102
v_fmac_f32 v99, v122, v103
v_fmac_f32 v96, v123, v104
v_fmac_f32 v97, v123, v105
v_fmac_f32 v98, v123, v106
v_fmac_f32 v99, v123, v107
v_fmac_f32 v96, v124, v108
v_fmac_f32 v97, v124, v109
v_fmac_f32 v98, v124, v110
v_fmac_f32 v99, v124, v111
s_mov_b32 s32, 0
s_mov_b32 s33, 1
v_cndmask_b32_e64 v96, v96, v120, s[32:33]
v_cndmask_b32_e64 v97, v97, v127, s[32:33]
v_cndmask_b32_e64 v98, v98, 0, s[32:33]
v_cndmask_b32_e64 v99, v99, 0, s[32:33]
v_lshlrev_b32 v125, 4, v1
s_mov_b32 exec_lo, 0xffffffff
s_mov_b32 exec_hi, 0x1
buffer_store_dwordx4 v[96:99], v125, s[4:7], s88 offen sc1
s_mov_b64 exec, -1
s_nop 0
Lnp_96:
Ldk_95:
s_add_u32 s82, s82, 1
s_cmp_lt_u32 s82, 4
s_cbranch_scc1 L_cloop_f
s_waitcnt vmcnt(0)
s_endpgm
L_cslow:
s_mov_b32 s82, 0
L_cloop_s:
s_lshl_b32 s87, s82, 2
s_lshr_b32 s83, 0x2031, s87
s_and_b32 s83, s83, 3
s_and_b32 s84, s83, 1
s_lshr_b32 s85, s83, 1
s_mul_i32 s86, s83, 196608
s_cmp_eq_u32 s84, 0
s_cbranch_scc0 Lrx_97
v_mov_b32 v30, v6
v_mov_b32 v31, v7
s_nop 1
s_branch Lrxe_98
Lrx_97:
v_mov_b32 v30, v8
v_mov_b32 v31, v9
s_nop 1
Lrxe_98:
s_lshl_b32 s59, s90, 2
s_add_u32 s59, s59, s3
s_mul_i32 s59, s59, 5120
s_add_u32 s59, s59, s86
s_add_u32 s59, s59, 8192
s_lshr_b32 s87, s90, 1
s_lshl_b32 s87, s87, 12
s_and_b32 s88, s90, 1
s_lshl3_add_u32 s87, s88, s87
s_add_u32 s49, s86, 172032
s_add_u32 s87, s87, s49
s_lshl_b32 s88, s91, 2
s_add_u32 s88, s88, s3
s_lshl_b32 s88, s88, 8
s_add_u32 s48, s87, s88
s_add_u32 s50, s49, 4096
s_add_u32 s51, s49, 8192
s_add_u32 s52, s49, 12288
s_lshl_b32 s53, s80, 2
s_add_u32 s53, s53, s3
s_lshl_b32 s53, s53, 5
s_add_u32 s54, s86, 188416
s_add_u32 s53, s53, s54
s_mul_i32 s87, s3, 896
s_add_u32 s54, s54, s87
s_add_u32 s56, s86, 192512
s_lshl_b32 s55, s80, 6
s_add_u32 s55, s55, s56
s_add_u32 s94, s86, 393216
s_lshl_b32 s57, s80, 8
s_lshl_b32 s87, s3, 6
s_add_u32 s57, s57, s87
s_add_u32 s57, s57, s94
s_lshl_b32 s88, s84, 8
s_add_u32 s58, s87, s88
s_add_u32 s58, s58, 152896
s_lshl_b32 s68, s84, 10
s_lshl_b32 s88, s80, 5
s_add_u32 s68, s68, s88
v_mov_b64 v[128:129], 0
v_mov_b64 v[132:133], 0
v_mov_b64 v[56:57], 0
v_mov_b64 v[58:59], 0
buffer_load_dwordx4 v[64:67], v27, s[4:7], s59 offen offset:0 sc1
buffer_load_dwordx2 v[80:81], v28, s[4:7], s59 offen offset:0 sc1
buffer_load_dwordx4 v[68:71], v27, s[4:7], s59 offen offset:640 sc1
buffer_load_dwordx2 v[82:83], v28, s[4:7], s59 offen offset:640 sc1
buffer_load_dwordx4 v[72:75], v27, s[4:7], s59 offen offset:1280 sc1
buffer_load_dwordx2 v[84:85], v28, s[4:7], s59 offen offset:1280 sc1
buffer_load_dwordx4 v[76:79], v27, s[4:7], s59 offen offset:1920 sc1
buffer_load_dwordx2 v[86:87], v28, s[4:7], s59 offen offset:1920 sc1
Lpoll_99:
s_waitcnt vmcnt(0)
v_max3_u32 v88, v64, v65, v66
v_max3_u32 v88, v88, v67, v80
v_max_u32 v88, v88, v81
v_max3_u32 v89, v68, v69, v70
v_max3_u32 v89, v89, v71, v82
v_max_u32 v89, v89, v83
v_max3_u32 v90, v72, v73, v74
v_max3_u32 v90, v90, v75, v84
v_max_u32 v90, v90, v85
v_max3_u32 v91, v76, v77, v78
v_max3_u32 v91, v91, v79, v86
v_max_u32 v91, v91, v87
v_max3_u32 v92, v88, v89, v90
v_max_u32 v92, v92, v91
v_cmp_eq_u32 vcc, -1, v92
s_nop 1
s_cbranch_vccz Lpdone_100
s_sub_u32 s81, s81, 1
s_cbranch_scc1 Lpbud_101
v_cmp_eq_u32 vcc, -1, v88
s_nop 1
s_cbranch_vccz Lpsk_102
buffer_load_dwordx4 v[64:67], v27, s[4:7], s59 offen offset:0 sc1
buffer_load_dwordx2 v[80:81], v28, s[4:7], s59 offen offset:0 sc1
Lpsk_102:
v_cmp_eq_u32 vcc, -1, v89
s_nop 1
s_cbranch_vccz Lpsk_103
buffer_load_dwordx4 v[68:71], v27, s[4:7], s59 offen offset:640 sc1
buffer_load_dwordx2 v[82:83], v28, s[4:7], s59 offen offset:640 sc1
Lpsk_103:
v_cmp_eq_u32 vcc, -1, v90
s_nop 1
s_cbranch_vccz Lpsk_104
buffer_load_dwordx4 v[72:75], v27, s[4:7], s59 offen offset:1280 sc1
buffer_load_dwordx2 v[84:85], v28, s[4:7], s59 offen offset:1280 sc1
Lpsk_104:
v_cmp_eq_u32 vcc, -1, v91
s_nop 1
s_cbranch_vccz Lpsk_105
buffer_load_dwordx4 v[76:79], v27, s[4:7], s59 offen offset:1920 sc1
buffer_load_dwordx2 v[86:87], v28, s[4:7], s59 offen offset:1920 sc1
Lpsk_105:
s_branch Lpoll_99
Lpbud_101:
s_mov_b32 s81, 0
Lpdone_100:
v_max3_f32 v88, v80, v82, v84
v_max_f32 v88, v88, v86
v_mov_b32 v94, v88
s_nop 1
v_permlane32_swap_b32 v88, v94
v_max_f32 v88, v88, v94
v_sub_f32 v89, v80, v88
v_sub_f32 v90, v82, v88
v_sub_f32 v91, v84, v88
v_sub_f32 v92, v86, v88
v_exp_f32 v89, v89
v_exp_f32 v90, v90
v_exp_f32 v91, v91
v_exp_f32 v92, v92
v_mul_f32 v93, v89, v81
v_pk_mul_f32 v[64:65], v[88:89], v[64:65] op_sel:[1,0] op_sel_hi:[1,1]
v_pk_mul_f32 v[66:67], v[88:89], v[66:67] op_sel:[1,0] op_sel_hi:[1,1]
v_fmac_f32 v93, v90, v83
v_pk_fma_f32 v[64:65], v[90:91], v[68:69], v[64:65] op_sel:[0,0,0] op_sel_hi:[0,1,1]
v_pk_fma_f32 v[66:67], v[90:91], v[70:71], v[66:67] op_sel:[0,0,0] op_sel_hi:[0,1,1]
v_fmac_f32 v93, v91, v85
v_pk_fma_f32 v[64:65], v[90:91], v[72:73], v[64:65] op_sel:[1,0,0] op_sel_hi:[1,1,1]
v_pk_fma_f32 v[66:67], v[90:91], v[74:75], v[66:67] op_sel:[1,0,0] op_sel_hi:[1,1,1]
v_fmac_f32 v93, v92, v87
v_pk_fma_f32 v[64:65], v[92:93], v[76:77], v[64:65] op_sel:[0,0,0] op_sel_hi:[0,1,1]
v_pk_fma_f32 v[66:67], v[92:93], v[78:79], v[66:67] op_sel:[0,0,0] op_sel_hi:[0,1,1]
v_mov_b32 v94, v93
s_nop 0
v_permlane32_swap_b32 v64, v66
v_permlane32_swap_b32 v93, v94
v_permlane32_swap_b32 v65, v67
v_add_f32 v93, v93, v94
v_pk_add_f32 v[64:65], v[64:65], v[66:67]
v_rcp_f32 v93, v93
s_nop 0
v_mul_f32 v64, v64, v93
v_mul_f32 v65, v65, v93
v_cvt_pk_bf16_f32 v64, v64, v65
ds_write_b32 v38, v64 offset:0
s_waitcnt lgkmcnt(0)
s_barrier
ds_read_b128 v[64:67], v10 offset:0
ds_read_b128 v[68:71], v10 offset:128
ds_read_b128 v[72:75], v10 offset:256
ds_read_b128 v[76:79], v10 offset:384
ds_read_b128 v[80:83], v10 offset:512
ds_read_b128 v[84:87], v10 offset:640
ds_read_b128 v[88:91], v10 offset:768
ds_read_b128 v[92:95], v10 offset:896
s_waitcnt lgkmcnt(7)
v_smfmac_f32_16x16x64_bf16 v[128:131], v[64:67], a[128:135], v13
v_smfmac_f32_16x16x64_bf16 v[132:135], v[64:67], a[192:199], v13
s_waitcnt lgkmcnt(6)
v_smfmac_f32_16x16x64_bf16 v[128:131], v[68:71], a[136:143], v13
v_smfmac_f32_16x16x64_bf16 v[132:135], v[68:71], a[200:207], v13
s_waitcnt lgkmcnt(5)
v_smfmac_f32_16x16x64_bf16 v[128:131], v[72:75], a[144:151], v13
v_smfmac_f32_16x16x64_bf16 v[132:135], v[72:75], a[208:215], v13
s_waitcnt lgkmcnt(4)
v_smfmac_f32_16x16x64_bf16 v[128:131], v[76:79], a[152:159], v13
v_smfmac_f32_16x16x64_bf16 v[132:135], v[76:79], a[216:223], v13
s_waitcnt lgkmcnt(3)
v_smfmac_f32_16x16x64_bf16 v[128:131], v[80:83], a[160:167], v13
v_smfmac_f32_16x16x64_bf16 v[132:135], v[80:83], a[224:231], v13
s_waitcnt lgkmcnt(2)
v_smfmac_f32_16x16x64_bf16 v[128:131], v[84:87], a[168:175], v13
v_smfmac_f32_16x16x64_bf16 v[132:135], v[84:87], a[232:239], v13
s_waitcnt lgkmcnt(1)
v_smfmac_f32_16x16x64_bf16 v[128:131], v[88:91], a[176:183], v13
v_smfmac_f32_16x16x64_bf16 v[132:135], v[88:91], a[240:247], v13
s_waitcnt lgkmcnt(0)
v_smfmac_f32_16x16x64_bf16 v[128:131], v[92:95], a[184:191], v13
v_smfmac_f32_16x16x64_bf16 v[132:135], v[92:95], a[248:255], v13
s_mov_b64 exec, s[64:65]
s_nop 5
v_add_f32_dpp v64, v128, v129 quad_perm:[0,1,2,3] row_mask:0x1 bank_mask:0xf
v_add_f32_dpp v64, v132, v133 quad_perm:[0,1,2,3] row_mask:0x2 bank_mask:0xf
buffer_store_dword v64, v19, s[4:7], s48 offen sc1
s_mov_b64 exec, -1
buffer_load_dwordx4 v[64:67], v20, s[4:7], s49 offen sc1
buffer_load_dwordx4 v[68:71], v20, s[4:7], s50 offen sc1
buffer_load_dwordx4 v[72:75], v20, s[4:7], s51 offen sc1
buffer_load_dwordx4 v[76:79], v20, s[4:7], s52 offen sc1
Lpoll_106:
s_waitcnt vmcnt(0)
v_max3_u32 v80, v64, v65, v66
v_max_u32 v80, v80, v67
v_max3_u32 v81, v68, v69, v70
v_max_u32 v81, v81, v71
v_max3_u32 v82, v72, v73, v74
v_max_u32 v82, v82, v75
v_max3_u32 v83, v76, v77, v78
v_max_u32 v83, v83, v79
v_max3_u32 v84, v80, v81, v82
v_max_u32 v84, v84, v83
v_cmp_eq_u32 vcc, -1, v84
s_nop 1
s_cbranch_vccz Lpdone_107
s_sub_u32 s81, s81, 1
s_cbranch_scc1 Lpbud_108
v_cmp_eq_u32 vcc, -1, v80
s_nop 1
s_cbranch_vccz Lpsk_109
buffer_load_dwordx4 v[64:67], v20, s[4:7], s49 offen sc1
Lpsk_109:
v_cmp_eq_u32 vcc, -1, v81
s_nop 1
s_cbranch_vccz Lpsk_110
buffer_load_dwordx4 v[68:71], v20, s[4:7], s50 offen sc1
Lpsk_110:
v_cmp_eq_u32 vcc, -1, v82
s_nop 1
s_cbranch_vccz Lpsk_111
buffer_load_dwordx4 v[72:75], v20, s[4:7], s51 offen sc1
Lpsk_111:
v_cmp_eq_u32 vcc, -1, v83
s_nop 1
s_cbranch_vccz Lpsk_112
buffer_load_dwordx4 v[76:79], v20, s[4:7], s52 offen sc1
Lpsk_112:
s_branch Lpoll_106
Lpbud_108:
s_mov_b32 s81, 0
Lpdone_107:
v_pk_add_f32 v[64:65], v[64:65], v[66:67]
v_pk_add_f32 v[68:69], v[68:69], v[70:71]
v_pk_add_f32 v[72:73], v[72:73], v[74:75]
v_pk_add_f32 v[76:77], v[76:77], v[78:79]
v_pk_add_f32 v[64:65], v[64:65], v[68:69]
v_pk_add_f32 v[72:73], v[72:73], v[76:77]
v_pk_add_f32 v[30:31], v[30:31], v[64:65]
v_pk_add_f32 v[30:31], v[30:31], v[72:73]
v_cvt_pk_bf16_f32 v98, v30, v31
v_add_f32 v96, v30, v31
v_mul_f32 v97, v30, v30
ds_write_b32 v3, v98 offset:1024
v_fmac_f32 v97, v31, v31
ds_write_b64 v5, v[30:31] offset:3072
v_add_f32_dpp v96, v96, v96 row_shr:1 row_mask:0xf bank_mask:0xf
v_add_f32_dpp v97, v97, v97 row_shr:1 row_mask:0xf bank_mask:0xf
s_nop 0
v_add_f32_dpp v96, v96, v96 row_shr:2 row_mask:0xf bank_mask:0xf
v_add_f32_dpp v97, v97, v97 row_shr:2 row_mask:0xf bank_mask:0xf
s_nop 0
v_add_f32_dpp v96, v96, v96 row_shr:4 row_mask:0xf bank_mask:0xf
v_add_f32_dpp v97, v97, v97 row_shr:4 row_mask:0xf bank_mask:0xf
s_nop 0
v_add_f32_dpp v96, v96, v96 row_shr:8 row_mask:0xf bank_mask:0xf
v_add_f32_dpp v97, v97, v97 row_shr:8 row_mask:0xf bank_mask:0xf
s_nop 0
v_add_f32_dpp v96, v96, v96 row_bcast:15 row_mask:0xa bank_mask:0xf
v_add_f32_dpp v97, v97, v97 row_bcast:15 row_mask:0xa bank_mask:0xf
s_nop 0
v_add_f32_dpp v96, v96, v96 row_bcast:31 row_mask:0xc bank_mask:0xf
v_add_f32_dpp v97, v97, v97 row_bcast:31 row_mask:0xc bank_mask:0xf
s_mov_b32 exec_lo, 0
s_mov_b32 exec_hi, 0x80000000
ds_write_b64 v21, v[96:97] offset:5120
s_mov_b64 exec, -1
s_waitcnt lgkmcnt(0)
s_barrier
ds_read_b128 v[128:131], v23 offset:5120
ds_read_b128 v[60:63], v23 offset:5136
ds_read_b128 v[64:67], v11 offset:0
ds_read_b128 v[68:71], v11 offset:128
ds_read_b128 v[72:75], v11 offset:256
ds_read_b128 v[76:79], v11 offset:384
ds_read_b128 v[80:83], v11 offset:512
ds_read_b128 v[84:87], v11 offset:640
ds_read_b128 v[88:91], v11 offset:768
ds_read_b128 v[92:95], v11 offset:896
s_waitcnt lgkmcnt(8)
v_mov_b32 v99, s66
s_waitcnt lgkmcnt(7)
v_smfmac_f32_16x16x64_bf16 v[56:59], v[64:67], v[192:199], v13
v_add_f32 v128, v128, v130
s_waitcnt lgkmcnt(6)
v_smfmac_f32_16x16x64_bf16 v[56:59], v[68:71], v[200:207], v13
v_add_f32 v129, v129, v131
s_waitcnt lgkmcnt(5)
v_smfmac_f32_16x16x64_bf16 v[56:59], v[72:75], v[208:215], v13
v_add_f32 v60, v60, v62
s_waitcnt lgkmcnt(4)
v_smfmac_f32_16x16x64_bf16 v[56:59], v[76:79], v[216:223], v13
v_add_f32 v61, v61, v63
s_waitcnt lgkmcnt(3)
v_smfmac_f32_16x16x64_bf16 v[56:59], v[80:83], v[224:231], v13
v_add_f32 v128, v128, v60
s_waitcnt lgkmcnt(2)
v_smfmac_f32_16x16x64_bf16 v[56:59], v[84:87], v[232:239], v13
v_add_f32 v129, v129, v61
s_waitcnt lgkmcnt(1)
v_smfmac_f32_16x16x64_bf16 v[56:59], v[88:91], v[240:247], v13
v_mul_f32 v132, 0x3b000000, v128
s_waitcnt lgkmcnt(0)
v_smfmac_f32_16x16x64_bf16 v[56:59], v[92:95], v[248:255], v13
v_mul_f32 v129, 0x3b000000, v129
v_fma_f32 v129, -v132, v132, v129
v_add_f32 v129, 0x3727c5ac, v129
v_max_f32 v129, 0x3727c5ac, v129
v_rsq_f32 v133, v129
s_nop 2
v_add_f32 v64, v56, v57
v_add_f32 v66, v58, v59
v_fma_f32 v64, -v132, v66, v64
v_fma_f32 v64, v64, v133, v22
v_mul_f32 v65, v64, v64
v_fma_f32 v65, v65, s67, v99
v_mul_f32 v65, v65, v64
v_exp_f32 v65, v65
s_nop 0
v_add_f32 v65, 1.0, v65
v_rcp_f32 v65, v65
s_nop 0
v_mul_f32 v64, v64, v65
s_nop 1
v_mov_b32_dpp v65, v64 quad_perm:[1,1,3,3] row_mask:0xf bank_mask:0xf
v_cvt_pk_bf16_f32 v64, v64, v65
s_mov_b64 exec, s[60:61]
buffer_store_dword v64, v15, s[4:7], s53 offen sc1
s_mov_b32 exec_lo, 0xffffffff
s_mov_b32 exec_hi, 0xffffff
v_mov_b64 v[128:129], 0
s_nop 1
Lpoll_113:
buffer_load_dwordx4 v[64:67], v37, s[4:7], s54 offen sc1
s_waitcnt vmcnt(0)
v_max3_u32 v68, v64, v65, v66
v_max_u32 v68, v68, v67
v_cmp_eq_u32 vcc, -1, v68
s_nop 1
s_cbranch_vccz Lpdone_114
s_sub_u32 s81, s81, 1
s_cbranch_scc0 Lpoll_113
s_mov_b32 s81, 0
Lpdone_114:
ds_write_b128 v33, v[64:67]
s_mov_b64 exec, -1
ds_read_b128 v[64:67], v14 offset:0
ds_read_b128 v[68:71], v14 offset:128
ds_read_b128 v[72:75], v14 offset:256
ds_read_b128 v[76:79], v14 offset:384
ds_read_b128 v[80:83], v14 offset:512
ds_read_b128 v[84:87], v14 offset:640
ds_read_b128 v[88:91], v14 offset:768
s_waitcnt lgkmcnt(6)
v_smfmac_f32_16x16x64_bf16 v[128:131], v[64:67], v[136:143], v13
s_waitcnt lgkmcnt(5)
v_smfmac_f32_16x16x64_bf16 v[128:131], v[68:71], v[144:151], v13
s_waitcnt lgkmcnt(4)
v_smfmac_f32_16x16x64_bf16 v[128:131], v[72:75], v[152:159], v13
s_waitcnt lgkmcnt(3)
v_smfmac_f32_16x16x64_bf16 v[128:131], v[76:79], v[160:167], v13
s_waitcnt lgkmcnt(2)
v_smfmac_f32_16x16x64_bf16 v[128:131], v[80:83], v[168:175], v13
s_waitcnt lgkmcnt(1)
v_smfmac_f32_16x16x64_bf16 v[128:131], v[84:87], v[176:183], v13
s_waitcnt lgkmcnt(0)
v_smfmac_f32_16x16x64_bf16 v[128:131], v[88:91], v[184:191], v13
s_mov_b32 exec_lo, 0xffff
s_mov_b32 exec_hi, 0
s_nop 5
v_add_f32 v128, v128, v129
ds_write_b32 v35, v128
s_mov_b64 exec, -1
ds_read_b32 v68, v24
s_waitcnt lgkmcnt(0)
v_add_f32 v68, v68, v26
s_barrier
ds_read_b32 v64, v36 offset:0
ds_read_b32 v65, v36 offset:64
ds_read_b32 v66, v36 offset:128
ds_read_b32 v67, v36 offset:192
s_waitcnt lgkmcnt(0)
v_add_f32 v64, v64, v65
v_add_f32 v66, v66, v67
v_add_f32 v64, v64, v68
v_add_f32 v64, v64, v66
s_cmp_eq_u32 s85, 1
s_mov_b64 exec, s[62:63]
s_cbranch_scc1 Lout_115
buffer_store_dword v64, v39, s[4:7], s55 offen sc1
s_mov_b64 exec, -1
v_mov_b64 v[52:53], 0
v_mov_b64 v[54:55], 0
v_mov_b64 v[56:57], 0
v_mov_b64 v[58:59], 0
s_nop 1
Lpoll_117:
buffer_load_dwordx2 v[30:31], v4, s[4:7], s56 offen sc1
s_waitcnt vmcnt(0)
v_max_u32 v64, v30, v31
v_cmp_eq_u32 vcc, -1, v64
s_nop 1
s_cbranch_vccz Lpdone_118
s_sub_u32 s81, s81, 1
s_cbranch_scc0 Lpoll_117
s_mov_b32 s81, 0
Lpdone_118:
v_cvt_pk_bf16_f32 v98, v30, v31
v_add_f32 v96, v30, v31
v_mul_f32 v97, v30, v30
ds_write_b32 v3, v98 offset:2048
v_fmac_f32 v97, v31, v31
v_add_f32_dpp v96, v96, v96 row_shr:1 row_mask:0xf bank_mask:0xf
s_nop 0
v_add_f32_dpp v97, v97, v97 row_shr:1 row_mask:0xf bank_mask:0xf
v_add_f32_dpp v96, v96, v96 row_shr:2 row_mask:0xf bank_mask:0xf
s_nop 0
v_add_f32_dpp v97, v97, v97 row_shr:2 row_mask:0xf bank_mask:0xf
v_add_f32_dpp v96, v96, v96 row_shr:4 row_mask:0xf bank_mask:0xf
s_nop 0
v_add_f32_dpp v97, v97, v97 row_shr:4 row_mask:0xf bank_mask:0xf
v_add_f32_dpp v96, v96, v96 row_shr:8 row_mask:0xf bank_mask:0xf
s_nop 0
v_add_f32_dpp v97, v97, v97 row_shr:8 row_mask:0xf bank_mask:0xf
v_add_f32_dpp v96, v96, v96 row_bcast:15 row_mask:0xa bank_mask:0xf
s_nop 0
v_add_f32_dpp v97, v97, v97 row_bcast:15 row_mask:0xa bank_mask:0xf
v_add_f32_dpp v96, v96, v96 row_bcast:31 row_mask:0xc bank_mask:0xf
s_nop 0
v_add_f32_dpp v97, v97, v97 row_bcast:31 row_mask:0xc bank_mask:0xf
s_mov_b32 exec_lo, 0
s_mov_b32 exec_hi, 0x80000000
ds_write_b64 v21, v[96:97] offset:5152
s_mov_b64 exec, -1
s_waitcnt lgkmcnt(0)
s_barrier
ds_read_b128 v[128:131], v23 offset:5152
ds_read_b128 v[60:63], v23 offset:5168
ds_read_b128 v[64:67], v12 offset:0
ds_read_b128 v[68:71], v12 offset:128
ds_read_b128 v[72:75], v12 offset:256
ds_read_b128 v[76:79], v12 offset:384
ds_read_b128 v[80:83], v12 offset:512
ds_read_b128 v[84:87], v12 offset:640
ds_read_b128 v[88:91], v12 offset:768
ds_read_b128 v[92:95], v12 offset:896
s_waitcnt lgkmcnt(8)
s_waitcnt lgkmcnt(7)
v_smfmac_f32_16x16x64_bf16 v[52:55], v[64:67], a[0:7], v13
v_add_f32 v128, v128, v130
v_smfmac_f32_16x16x64_bf16 v[56:59], v[64:67], a[64:71], v13
v_add_f32 v129, v129, v131
s_waitcnt lgkmcnt(6)
v_smfmac_f32_16x16x64_bf16 v[52:55], v[68:71], a[8:15], v13
v_add_f32 v60, v60, v62
v_smfmac_f32_16x16x64_bf16 v[56:59], v[68:71], a[72:79], v13
v_add_f32 v61, v61, v63
s_waitcnt lgkmcnt(5)
v_smfmac_f32_16x16x64_bf16 v[52:55], v[72:75], a[16:23], v13
v_add_f32 v128, v128, v60
v_smfmac_f32_16x16x64_bf16 v[56:59], v[72:75], a[80:87], v13
v_add_f32 v129, v129, v61
s_waitcnt lgkmcnt(4)
v_smfmac_f32_16x16x64_bf16 v[52:55], v[76:79], a[24:31], v13
v_mul_f32 v132, 0x3b000000, v128
v_smfmac_f32_16x16x64_bf16 v[56:59], v[76:79], a[88:95], v13
v_mul_f32 v129, 0x3b000000, v129
s_waitcnt lgkmcnt(3)
v_smfmac_f32_16x16x64_bf16 v[52:55], v[80:83], a[32:39], v13
v_fma_f32 v129, -v132, v132, v129
v_smfmac_f32_16x16x64_bf16 v[56:59], v[80:83], a[96:103], v13
v_add_f32 v129, 0x3727c5ac, v129
s_waitcnt lgkmcnt(2)
v_smfmac_f32_16x16x64_bf16 v[52:55], v[84:87], a[40:47], v13
v_max_f32 v129, 0x3727c5ac, v129
v_smfmac_f32_16x16x64_bf16 v[56:59], v[84:87], a[104:111], v13
v_rsq_f32 v133, v129
s_waitcnt lgkmcnt(1)
v_smfmac_f32_16x16x64_bf16 v[52:55], v[88:91], a[48:55], v13
v_mul_f32 v133, 0x3e0293ee, v133
v_smfmac_f32_16x16x64_bf16 v[56:59], v[88:91], a[112:119], v13
v_add_u32 v100, s58, v16
s_waitcnt lgkmcnt(0)
v_smfmac_f32_16x16x64_bf16 v[52:55], v[92:95], a[56:63], v13
v_smfmac_f32_16x16x64_bf16 v[56:59], v[92:95], a[120:127], v13
s_nop 6
v_add_f32_dpp v96, v52, v53 quad_perm:[0,1,2,3] row_mask:0x1 bank_mask:0xf
v_add_f32_dpp v97, v54, v55 quad_perm:[0,1,2,3] row_mask:0x1 bank_mask:0xf
v_add_f32_dpp v96, v56, v57 quad_perm:[0,1,2,3] row_mask:0x2 bank_mask:0xf
v_add_f32_dpp v97, v58, v59 quad_perm:[0,1,2,3] row_mask:0x2 bank_mask:0xf
v_fma_f32 v96, -v132, v97, v96
v_mul_f32 v96, v96, v133
s_nop 1
v_mov_b32_dpp v98, v96 quad_perm:[1,1,3,3] row_mask:0xf bank_mask:0xf
s_mov_b32 exec_lo, 0x55555555
s_mov_b32 exec_hi, 0
v_cvt_pk_bf16_f32 v96, v96, v98
buffer_store_dword v96, v17, s[4:7], s57 offen offset:0 sc1
ds_write_b32 v100, v96
s_mov_b64 exec, -1
s_cmp_eq_u32 s84, 0
s_cbranch_scc0 Lsx_119
v_mov_b32 v6, v30
v_mov_b32 v7, v31
s_nop 1
s_branch Lsxe_120
Lsx_119:
v_mov_b32 v8, v30
v_mov_b32 v9, v31
s_nop 1
Lsxe_120:
s_waitcnt lgkmcnt(0)
s_barrier
s_lshl_b32 s87, s84, 8
v_add_u32 v96, s87, v2
ds_read_b128 v[52:55], v96 offset:5440
ds_read_b128 v[56:59], v96 offset:5504
ds_read_b128 v[60:63], v96 offset:5568
ds_read_b128 v[64:67], v96 offset:5632
s_xor_b32 s88, s84, 1
s_lshl_b32 s88, s88, 14
s_add_u32 s88, s88, s89
v_and_b32 v82, 15, v1
v_and_b32 v83, 7, v1
v_lshlrev_b32 v83, 1, v83
v_lshrrev_b32 v41, 4, v1
v_xor_b32 v83, v83, v41
v_lshlrev_b32 v83, 4, v83
v_lshlrev_b32 v82, 8, v82
v_add_u32 v82, v82, v83
v_add_u32 v40, s88, v82
v_xor_b32 v41, 64, v40
v_xor_b32 v42, 128, v40
v_xor_b32 v43, 192, v40
v_lshrrev_b32 v82, 2, v1
v_and_b32 v83, 7, v82
v_lshlrev_b32 v83, 1, v83
v_lshlrev_b32 v82, 8, v82
v_bfe_u32 v45, v1, 1, 1
v_xor_b32 v83, v83, v45
v_lshlrev_b32 v83, 4, v83
v_add_u32 v82, v82, v83
v_and_b32 v83, 1, v1
v_lshlrev_b32 v83, 3, v83
v_add_u32 v82, v82, v83
v_add_u32 v44, s88, v82
v_xor_b32 v45, 32, v44
v_xor_b32 v46, 64, v44
v_xor_b32 v47, 96, v44
v_xor_b32 v48, 128, v44
v_xor_b32 v49, 160, v44
v_xor_b32 v50, 192, v44
v_xor_b32 v51, 224, v44
v_mov_b32 v80, 0xff800000
v_mov_b32 v81, 0
v_mov_b32 v76, 0
v_mov_b32 v77, 0
v_mov_b32 v78, 0
v_mov_b32 v79, 0
s_waitcnt lgkmcnt(0)
ds_read_b128 v[96:99], v40 offset:0
ds_read_b128 v[100:103], v41 offset:0
ds_read_b128 v[104:107], v42 offset:0
ds_read_b128 v[108:111], v43 offset:0
ds_read_b128 v[112:115], v40 offset:4096
ds_read_b128 v[116:119], v41 offset:4096
ds_read_b128 v[120:123], v42 offset:4096
ds_read_b128 v[124:127], v43 offset:4096
s_waitcnt lgkmcnt(7)
v_mfma_f32_16x16x32_bf16 v[68:71], v[96:99], v[52:55], 0
s_waitcnt lgkmcnt(6)
v_mfma_f32_16x16x32_bf16 v[68:71], v[100:103], v[56:59], v[68:71]
s_waitcnt lgkmcnt(5)
v_mfma_f32_16x16x32_bf16 v[68:71], v[104:107], v[60:63], v[68:71]
s_waitcnt lgkmcnt(4)
v_mfma_f32_16x16x32_bf16 v[68:71], v[108:111], v[64:67], v[68:71]
s_waitcnt lgkmcnt(3)
v_mfma_f32_16x16x32_bf16 v[72:75], v[112:115], v[52:55], 0
s_waitcnt lgkmcnt(2)
v_mfma_f32_16x16x32_bf16 v[72:75], v[116:119], v[56:59], v[72:75]
s_waitcnt lgkmcnt(1)
v_mfma_f32_16x16x32_bf16 v[72:75], v[120:123], v[60:63], v[72:75]
s_waitcnt lgkmcnt(0)
v_mfma_f32_16x16x32_bf16 v[72:75], v[124:127], v[64:67], v[72:75]
ds_read_b64_tr_b16 v[96:97], v44 offset:8192
ds_read_b64_tr_b16 v[98:99], v44 offset:12288
ds_read_b64_tr_b16 v[100:101], v45 offset:8192
ds_read_b64_tr_b16 v[102:103], v45 offset:12288
ds_read_b64_tr_b16 v[104:105], v46 offset:8192
ds_read_b64_tr_b16 v[106:107], v46 offset:12288
ds_read_b64_tr_b16 v[108:109], v47 offset:8192
ds_read_b64_tr_b16 v[110:111], v47 offset:12288
ds_read_b64_tr_b16 v[112:113], v48 offset:8192
ds_read_b64_tr_b16 v[114:115], v48 offset:12288
ds_read_b64_tr_b16 v[116:117], v49 offset:8192
ds_read_b64_tr_b16 v[118:119], v49 offset:12288
ds_read_b64_tr_b16 v[120:121], v50 offset:8192
ds_read_b64_tr_b16 v[122:123], v50 offset:12288
ds_read_b64_tr_b16 v[124:125], v51 offset:8192
ds_read_b64_tr_b16 v[126:127], v51 offset:12288
v_max3_f32 v82, v68, v69, v70
v_max3_f32 v83, v72, v73, v74
v_max3_f32 v82, v82, v71, v75
v_max3_f32 v82, v82, v83, v80
v_mov_b32 v83, v82
s_nop 1
v_permlane16_swap_b32 v82, v83
v_max_f32 v82, v82, v83
v_mov_b32 v83, v82
s_nop 1
v_permlane32_swap_b32 v82, v83
v_max_f32 v82, v82, v83
v_sub_f32 v83, v80, v82
v_exp_f32 v83, v83
v_mov_b32 v80, v82
v_sub_f32 v68, v68, v82
v_sub_f32 v69, v69, v82
v_sub_f32 v70, v70, v82
v_sub_f32 v71, v71, v82
v_sub_f32 v72, v72, v82
v_sub_f32 v73, v73, v82
v_sub_f32 v74, v74, v82
v_sub_f32 v75, v75, v82
v_exp_f32 v68, v68
v_exp_f32 v69, v69
v_exp_f32 v70, v70
v_exp_f32 v71, v71
v_exp_f32 v72, v72
v_exp_f32 v73, v73
v_exp_f32 v74, v74
v_exp_f32 v75, v75
v_mul_f32 v81, v81, v83
v_mul_f32 v76, v76, v83
v_mul_f32 v77, v77, v83
v_mul_f32 v78, v78, v83
v_mul_f32 v79, v79, v83
v_add_f32 v84, v68, v69
v_add_f32 v85, v70, v71
v_add_f32 v84, v84, v72
v_add_f32 v85, v85, v73
v_add_f32 v84, v84, v74
v_add_f32 v85, v85, v75
v_add_f32 v81, v81, v84
v_add_f32 v81, v81, v85
v_cvt_pk_bf16_f32 v68, v68, v69
v_cvt_pk_bf16_f32 v69, v70, v71
v_cvt_pk_bf16_f32 v70, v72, v73
v_cvt_pk_bf16_f32 v71, v74, v75
v_cndmask_b32_e64 v88, 0, v68, s[16:17]
v_cndmask_b32_e64 v89, 0, v69, s[16:17]
v_cndmask_b32_e64 v90, 0, v70, s[16:17]
v_cndmask_b32_e64 v91, 0, v71, s[16:17]
v_cndmask_b32_e64 v92, 0, v68, s[18:19]
v_cndmask_b32_e64 v93, 0, v69, s[18:19]
v_cndmask_b32_e64 v94, 0, v70, s[18:19]
v_cndmask_b32_e64 v95, 0, v71, s[18:19]
s_waitcnt lgkmcnt(14)
v_mfma_f32_16x16x32_bf16 v[76:79], v[96:99], v[88:91], v[76:79]
v_cndmask_b32_e64 v88, 0, v68, s[20:21]
v_cndmask_b32_e64 v89, 0, v69, s[20:21]
v_cndmask_b32_e64 v90, 0, v70, s[20:21]
v_cndmask_b32_e64 v91, 0, v71, s[20:21]
s_waitcnt lgkmcnt(12)
v_mfma_f32_16x16x32_bf16 v[76:79], v[100:103], v[92:95], v[76:79]
v_cndmask_b32_e64 v92, 0, v68, s[22:23]
v_cndmask_b32_e64 v93, 0, v69, s[22:23]
v_cndmask_b32_e64 v94, 0, v70, s[22:23]
v_cndmask_b32_e64 v95, 0, v71, s[22:23]
s_waitcnt lgkmcnt(10)
v_mfma_f32_16x16x32_bf16 v[76:79], v[104:107], v[88:91], v[76:79]
v_cndmask_b32_e64 v88, 0, v68, s[24:25]
v_cndmask_b32_e64 v89, 0, v69, s[24:25]
v_cndmask_b32_e64 v90, 0, v70, s[24:25]
v_cndmask_b32_e64 v91, 0, v71, s[24:25]
s_waitcnt lgkmcnt(8)
v_mfma_f32_16x16x32_bf16 v[76:79], v[108:111], v[92:95], v[76:79]
v_cndmask_b32_e64 v92, 0, v68, s[26:27]
v_cndmask_b32_e64 v93, 0, v69, s[26:27]
v_cndmask_b32_e64 v94, 0, v70, s[26:27]
v_cndmask_b32_e64 v95, 0, v71, s[26:27]
s_waitcnt lgkmcnt(6)
v_mfma_f32_16x16x32_bf16 v[76:79], v[112:115], v[88:91], v[76:79]
v_cndmask_b32_e64 v88, 0, v68, s[28:29]
v_cndmask_b32_e64 v89, 0, v69, s[28:29]
v_cndmask_b32_e64 v90, 0, v70, s[28:29]
v_cndmask_b32_e64 v91, 0, v71, s[28:29]
s_waitcnt lgkmcnt(4)
v_mfma_f32_16x16x32_bf16 v[76:79], v[116:119], v[92:95], v[76:79]
v_cndmask_b32_e64 v92, 0, v68, s[30:31]
v_cndmask_b32_e64 v93, 0, v69, s[30:31]
v_cndmask_b32_e64 v94, 0, v70, s[30:31]
v_cndmask_b32_e64 v95, 0, v71, s[30:31]
s_waitcnt lgkmcnt(2)
v_mfma_f32_16x16x32_bf16 v[76:79], v[120:123], v[88:91], v[76:79]
s_waitcnt lgkmcnt(0)
v_mfma_f32_16x16x32_bf16 v[76:79], v[124:127], v[92:95], v[76:79]
s_mul_i32 s87, s3, 544
s_add_u32 s87, s87, 157696
v_mov_b32 v83, v81
s_nop 1
v_permlane16_swap_b32 v81, v83
v_add_f32 v81, v81, v83
v_mov_b32 v83, v81
s_nop 1
v_permlane32_swap_b32 v81, v83
v_add_f32 v81, v81, v83
v_and_b32 v96, 15, v1
v_lshlrev_b32 v96, 6, v96
v_lshrrev_b32 v97, 4, v1
v_lshlrev_b32 v97, 4, v97
v_add_u32 v96, v96, v97
v_add_u32 v96, s87, v96
v_mov_b32 v97, s87
s_mov_b32 exec_lo, 0xff00ff
s_mov_b32 exec_hi, 0xff00ff
ds_write_b128 v96, v[76:79]
s_mov_b32 exec_lo, 0x1
s_mov_b32 exec_hi, 0x0
ds_write_b64 v97, v[80:81] offset:512
s_mov_b64 exec, -1
s_waitcnt lgkmcnt(0)
s_barrier
s_cmp_lg_u32 s3, 0
s_cbranch_scc1 Lnp_121
s_lshl_b32 s88, s80, 3
s_add_u32 s88, s88, 7
s_mul_i32 s88, s88, 640
s_add_u32 s88, s88, s94
s_add_u32 s88, s88, 8192
s_mov_b32 s87, 157696
v_and_b32 v125, 31, v1
v_lshlrev_b32 v125, 4, v125
v_add_u32 v125, s87, v125
v_mov_b32 v126, s87
ds_read_b64 v[112:113], v126 offset:512
ds_read_b64 v[114:115], v126 offset:1056
ds_read_b64 v[116:117], v126 offset:1600
ds_read_b64 v[118:119], v126 offset:2144
ds_read_b128 v[96:99], v125 offset:0
ds_read_b128 v[100:103], v125 offset:544
ds_read_b128 v[104:107], v125 offset:1088
ds_read_b128 v[108:111], v125 offset:1632
s_waitcnt lgkmcnt(4)
v_max3_f32 v120, v112, v114, v116
v_max_f32 v120, v120, v118
v_sub_f32 v121, v112, v120
v_sub_f32 v122, v114, v120
v_sub_f32 v123, v116, v120
v_sub_f32 v124, v118, v120
v_exp_f32 v121, v121
v_exp_f32 v122, v122
v_exp_f32 v123, v123
v_exp_f32 v124, v124
v_mul_f32 v127, v121, v113
v_fmac_f32 v127, v122, v115
v_fmac_f32 v127, v123, v117
v_fmac_f32 v127, v124, v119
s_waitcnt lgkmcnt(0)
v_mul_f32 v96, v121, v96
v_mul_f32 v97, v121, v97
v_mul_f32 v98, v121, v98
v_mul_f32 v99, v121, v99
v_fmac_f32 v96, v122, v100
v_fmac_f32 v97, v122, v101
v_fmac_f32 v98, v122, v102
v_fmac_f32 v99, v122, v103
v_fmac_f32 v96, v123, v104
v_fmac_f32 v97, v123, v105
v_fmac_f32 v98, v123, v106
v_fmac_f32 v99, v123, v107
v_fmac_f32 v96, v124, v108
v_fmac_f32 v97, v124, v109
v_fmac_f32 v98, v124, v110
v_fmac_f32 v99, v124, v111
s_mov_b32 s32, 0
s_mov_b32 s33, 1
v_cndmask_b32_e64 v96, v96, v120, s[32:33]
v_cndmask_b32_e64 v97, v97, v127, s[32:33]
v_cndmask_b32_e64 v98, v98, 0, s[32:33]
v_cndmask_b32_e64 v99, v99, 0, s[32:33]
v_lshlrev_b32 v125, 4, v1
s_mov_b32 exec_lo, 0xffffffff
s_mov_b32 exec_hi, 0x1
buffer_store_dwordx4 v[96:99], v125, s[4:7], s88 offen sc1
s_mov_b64 exec, -1
s_nop 0
Lnp_121:
s_branch Lnext_116
Lout_115:
v_cvt_pk_bf16_f32 v64, v64, v64
buffer_store_short v64, v25, s[76:79], s68 offen
s_mov_b64 exec, -1
Lnext_116:
s_cmp_lg_u32 s82, 0
s_cbranch_scc1 Ldk_122
v_lshrrev_b32 v99, 4, v1
v_lshlrev_b32 v100, 1, v99
v_and_b32 v86, 15, v1
v_xor_b32 v86, v86, v100
v_lshlrev_b32 v86, 4, v86
v_lshlrev_b32 v99, 8, v99
v_add_u32 v86, v86, v99
v_xor_b32 v87, 0x80, v86
s_add_u32 s87, s3, 252
s_lshl_b32 s87, s87, 13
s_lshl_b32 s88, s80, 21
s_add_u32 s87, s87, s88
s_add_u32 s92, s87, 0
s_add_u32 s93, s89, 16384
s_mov_b32 m0, s93
s_nop 0
buffer_load_dwordx4 v86, s[8:11], s92 offen offset:0 nt lds
buffer_load_dwordx4 v87, s[8:11], s92 offen offset:1024 nt lds
buffer_load_dwordx4 v86, s[8:11], s92 offen offset:2048 nt lds
buffer_load_dwordx4 v87, s[8:11], s92 offen offset:3072 nt lds
s_add_u32 s92, s87, 4096
s_add_u32 s93, s89, 20480
s_mov_b32 m0, s93
s_nop 0
buffer_load_dwordx4 v86, s[8:11], s92 offen offset:0 nt lds
buffer_load_dwordx4 v87, s[8:11], s92 offen offset:1024 nt lds
buffer_load_dwordx4 v86, s[8:11], s92 offen offset:2048 nt lds
buffer_load_dwordx4 v87, s[8:11], s92 offen offset:3072 nt lds
s_add_u32 s92, s87, 0
s_add_u32 s93, s89, 24576
s_mov_b32 m0, s93
s_nop 0
buffer_load_dwordx4 v86, s[12:15], s92 offen offset:0 nt lds
buffer_load_dwordx4 v87, s[12:15], s92 offen offset:1024 nt lds
buffer_load_dwordx4 v86, s[12:15], s92 offen offset:2048 nt lds
buffer_load_dwordx4 v87, s[12:15], s92 offen offset:3072 nt lds
s_add_u32 s92, s87, 4096
s_add_u32 s93, s89, 28672
s_mov_b32 m0, s93
s_nop 0
buffer_load_dwordx4 v86, s[12:15], s92 offen offset:0 nt lds
buffer_load_dwordx4 v87, s[12:15], s92 offen offset:1024 nt lds
buffer_load_dwordx4 v86, s[12:15], s92 offen offset:2048 nt lds
buffer_load_dwordx4 v87, s[12:15], s92 offen offset:3072 nt lds
Ldk_122:
s_cmp_lg_u32 s82, 1
s_cbranch_scc1 Ldk_123
s_mov_b32 s84, 0
s_mov_b32 s94, 0
s_waitcnt vmcnt(0)
s_waitcnt lgkmcnt(0)
s_barrier
s_lshl_b32 s87, s84, 8
v_add_u32 v96, s87, v2
ds_read_b128 v[52:55], v96 offset:5440
ds_read_b128 v[56:59], v96 offset:5504
ds_read_b128 v[60:63], v96 offset:5568
ds_read_b128 v[64:67], v96 offset:5632
s_xor_b32 s88, s84, 1
s_lshl_b32 s88, s88, 14
s_add_u32 s88, s88, s89
v_and_b32 v82, 15, v1
v_and_b32 v83, 7, v1
v_lshlrev_b32 v83, 1, v83
v_lshrrev_b32 v41, 4, v1
v_xor_b32 v83, v83, v41
v_lshlrev_b32 v83, 4, v83
v_lshlrev_b32 v82, 8, v82
v_add_u32 v82, v82, v83
v_add_u32 v40, s88, v82
v_xor_b32 v41, 64, v40
v_xor_b32 v42, 128, v40
v_xor_b32 v43, 192, v40
v_lshrrev_b32 v82, 2, v1
v_and_b32 v83, 7, v82
v_lshlrev_b32 v83, 1, v83
v_lshlrev_b32 v82, 8, v82
v_bfe_u32 v45, v1, 1, 1
v_xor_b32 v83, v83, v45
v_lshlrev_b32 v83, 4, v83
v_add_u32 v82, v82, v83
v_and_b32 v83, 1, v1
v_lshlrev_b32 v83, 3, v83
v_add_u32 v82, v82, v83
v_add_u32 v44, s88, v82
v_xor_b32 v45, 32, v44
v_xor_b32 v46, 64, v44
v_xor_b32 v47, 96, v44
v_xor_b32 v48, 128, v44
v_xor_b32 v49, 160, v44
v_xor_b32 v50, 192, v44
v_xor_b32 v51, 224, v44
v_mov_b32 v80, 0xff800000
v_mov_b32 v81, 0
v_mov_b32 v76, 0
v_mov_b32 v77, 0
v_mov_b32 v78, 0
v_mov_b32 v79, 0
s_waitcnt lgkmcnt(0)
ds_read_b128 v[96:99], v40 offset:0
ds_read_b128 v[100:103], v41 offset:0
ds_read_b128 v[104:107], v42 offset:0
ds_read_b128 v[108:111], v43 offset:0
ds_read_b128 v[112:115], v40 offset:4096
ds_read_b128 v[116:119], v41 offset:4096
ds_read_b128 v[120:123], v42 offset:4096
ds_read_b128 v[124:127], v43 offset:4096
s_waitcnt lgkmcnt(7)
v_mfma_f32_16x16x32_bf16 v[68:71], v[96:99], v[52:55], 0
s_waitcnt lgkmcnt(6)
v_mfma_f32_16x16x32_bf16 v[68:71], v[100:103], v[56:59], v[68:71]
s_waitcnt lgkmcnt(5)
v_mfma_f32_16x16x32_bf16 v[68:71], v[104:107], v[60:63], v[68:71]
s_waitcnt lgkmcnt(4)
v_mfma_f32_16x16x32_bf16 v[68:71], v[108:111], v[64:67], v[68:71]
s_waitcnt lgkmcnt(3)
v_mfma_f32_16x16x32_bf16 v[72:75], v[112:115], v[52:55], 0
s_waitcnt lgkmcnt(2)
v_mfma_f32_16x16x32_bf16 v[72:75], v[116:119], v[56:59], v[72:75]
s_waitcnt lgkmcnt(1)
v_mfma_f32_16x16x32_bf16 v[72:75], v[120:123], v[60:63], v[72:75]
s_waitcnt lgkmcnt(0)
v_mfma_f32_16x16x32_bf16 v[72:75], v[124:127], v[64:67], v[72:75]
ds_read_b64_tr_b16 v[96:97], v44 offset:8192
ds_read_b64_tr_b16 v[98:99], v44 offset:12288
ds_read_b64_tr_b16 v[100:101], v45 offset:8192
ds_read_b64_tr_b16 v[102:103], v45 offset:12288
ds_read_b64_tr_b16 v[104:105], v46 offset:8192
ds_read_b64_tr_b16 v[106:107], v46 offset:12288
ds_read_b64_tr_b16 v[108:109], v47 offset:8192
ds_read_b64_tr_b16 v[110:111], v47 offset:12288
ds_read_b64_tr_b16 v[112:113], v48 offset:8192
ds_read_b64_tr_b16 v[114:115], v48 offset:12288
ds_read_b64_tr_b16 v[116:117], v49 offset:8192
ds_read_b64_tr_b16 v[118:119], v49 offset:12288
ds_read_b64_tr_b16 v[120:121], v50 offset:8192
ds_read_b64_tr_b16 v[122:123], v50 offset:12288
ds_read_b64_tr_b16 v[124:125], v51 offset:8192
ds_read_b64_tr_b16 v[126:127], v51 offset:12288
v_max3_f32 v82, v68, v69, v70
v_max3_f32 v83, v72, v73, v74
v_max3_f32 v82, v82, v71, v75
v_max3_f32 v82, v82, v83, v80
v_mov_b32 v83, v82
s_nop 1
v_permlane16_swap_b32 v82, v83
v_max_f32 v82, v82, v83
v_mov_b32 v83, v82
s_nop 1
v_permlane32_swap_b32 v82, v83
v_max_f32 v82, v82, v83
v_sub_f32 v83, v80, v82
v_exp_f32 v83, v83
v_mov_b32 v80, v82
v_sub_f32 v68, v68, v82
v_sub_f32 v69, v69, v82
v_sub_f32 v70, v70, v82
v_sub_f32 v71, v71, v82
v_sub_f32 v72, v72, v82
v_sub_f32 v73, v73, v82
v_sub_f32 v74, v74, v82
v_sub_f32 v75, v75, v82
v_exp_f32 v68, v68
v_exp_f32 v69, v69
v_exp_f32 v70, v70
v_exp_f32 v71, v71
v_exp_f32 v72, v72
v_exp_f32 v73, v73
v_exp_f32 v74, v74
v_exp_f32 v75, v75
v_mul_f32 v81, v81, v83
v_mul_f32 v76, v76, v83
v_mul_f32 v77, v77, v83
v_mul_f32 v78, v78, v83
v_mul_f32 v79, v79, v83
v_add_f32 v84, v68, v69
v_add_f32 v85, v70, v71
v_add_f32 v84, v84, v72
v_add_f32 v85, v85, v73
v_add_f32 v84, v84, v74
v_add_f32 v85, v85, v75
v_add_f32 v81, v81, v84
v_add_f32 v81, v81, v85
v_cvt_pk_bf16_f32 v68, v68, v69
v_cvt_pk_bf16_f32 v69, v70, v71
v_cvt_pk_bf16_f32 v70, v72, v73
v_cvt_pk_bf16_f32 v71, v74, v75
v_cndmask_b32_e64 v88, 0, v68, s[16:17]
v_cndmask_b32_e64 v89, 0, v69, s[16:17]
v_cndmask_b32_e64 v90, 0, v70, s[16:17]
v_cndmask_b32_e64 v91, 0, v71, s[16:17]
v_cndmask_b32_e64 v92, 0, v68, s[18:19]
v_cndmask_b32_e64 v93, 0, v69, s[18:19]
v_cndmask_b32_e64 v94, 0, v70, s[18:19]
v_cndmask_b32_e64 v95, 0, v71, s[18:19]
s_waitcnt lgkmcnt(14)
v_mfma_f32_16x16x32_bf16 v[76:79], v[96:99], v[88:91], v[76:79]
v_cndmask_b32_e64 v88, 0, v68, s[20:21]
v_cndmask_b32_e64 v89, 0, v69, s[20:21]
v_cndmask_b32_e64 v90, 0, v70, s[20:21]
v_cndmask_b32_e64 v91, 0, v71, s[20:21]
s_waitcnt lgkmcnt(12)
v_mfma_f32_16x16x32_bf16 v[76:79], v[100:103], v[92:95], v[76:79]
v_cndmask_b32_e64 v92, 0, v68, s[22:23]
v_cndmask_b32_e64 v93, 0, v69, s[22:23]
v_cndmask_b32_e64 v94, 0, v70, s[22:23]
v_cndmask_b32_e64 v95, 0, v71, s[22:23]
s_waitcnt lgkmcnt(10)
v_mfma_f32_16x16x32_bf16 v[76:79], v[104:107], v[88:91], v[76:79]
v_cndmask_b32_e64 v88, 0, v68, s[24:25]
v_cndmask_b32_e64 v89, 0, v69, s[24:25]
v_cndmask_b32_e64 v90, 0, v70, s[24:25]
v_cndmask_b32_e64 v91, 0, v71, s[24:25]
s_waitcnt lgkmcnt(8)
v_mfma_f32_16x16x32_bf16 v[76:79], v[108:111], v[92:95], v[76:79]
v_cndmask_b32_e64 v92, 0, v68, s[26:27]
v_cndmask_b32_e64 v93, 0, v69, s[26:27]
v_cndmask_b32_e64 v94, 0, v70, s[26:27]
v_cndmask_b32_e64 v95, 0, v71, s[26:27]
s_waitcnt lgkmcnt(6)
v_mfma_f32_16x16x32_bf16 v[76:79], v[112:115], v[88:91], v[76:79]
v_cndmask_b32_e64 v88, 0, v68, s[28:29]
v_cndmask_b32_e64 v89, 0, v69, s[28:29]
v_cndmask_b32_e64 v90, 0, v70, s[28:29]
v_cndmask_b32_e64 v91, 0, v71, s[28:29]
s_waitcnt lgkmcnt(4)
v_mfma_f32_16x16x32_bf16 v[76:79], v[116:119], v[92:95], v[76:79]
v_cndmask_b32_e64 v92, 0, v68, s[30:31]
v_cndmask_b32_e64 v93, 0, v69, s[30:31]
v_cndmask_b32_e64 v94, 0, v70, s[30:31]
v_cndmask_b32_e64 v95, 0, v71, s[30:31]
s_waitcnt lgkmcnt(2)
v_mfma_f32_16x16x32_bf16 v[76:79], v[120:123], v[88:91], v[76:79]
s_waitcnt lgkmcnt(0)
v_mfma_f32_16x16x32_bf16 v[76:79], v[124:127], v[92:95], v[76:79]
s_mul_i32 s87, s3, 544
s_add_u32 s87, s87, 157696
v_mov_b32 v83, v81
s_nop 1
v_permlane16_swap_b32 v81, v83
v_add_f32 v81, v81, v83
v_mov_b32 v83, v81
s_nop 1
v_permlane32_swap_b32 v81, v83
v_add_f32 v81, v81, v83
v_and_b32 v96, 15, v1
v_lshlrev_b32 v96, 6, v96
v_lshrrev_b32 v97, 4, v1
v_lshlrev_b32 v97, 4, v97
v_add_u32 v96, v96, v97
v_add_u32 v96, s87, v96
v_mov_b32 v97, s87
s_mov_b32 exec_lo, 0xff00ff
s_mov_b32 exec_hi, 0xff00ff
ds_write_b128 v96, v[76:79]
s_mov_b32 exec_lo, 0x1
s_mov_b32 exec_hi, 0x0
ds_write_b64 v97, v[80:81] offset:512
s_mov_b64 exec, -1
s_waitcnt lgkmcnt(0)
s_barrier
s_cmp_lg_u32 s3, 0
s_cbranch_scc1 Lnp_124
s_lshl_b32 s88, s80, 3
s_add_u32 s88, s88, 7
s_mul_i32 s88, s88, 640
s_add_u32 s88, s88, s94
s_add_u32 s88, s88, 8192
s_mov_b32 s87, 157696
v_and_b32 v125, 31, v1
v_lshlrev_b32 v125, 4, v125
v_add_u32 v125, s87, v125
v_mov_b32 v126, s87
ds_read_b64 v[112:113], v126 offset:512
ds_read_b64 v[114:115], v126 offset:1056
ds_read_b64 v[116:117], v126 offset:1600
ds_read_b64 v[118:119], v126 offset:2144
ds_read_b128 v[96:99], v125 offset:0
ds_read_b128 v[100:103], v125 offset:544
ds_read_b128 v[104:107], v125 offset:1088
ds_read_b128 v[108:111], v125 offset:1632
s_waitcnt lgkmcnt(4)
v_max3_f32 v120, v112, v114, v116
v_max_f32 v120, v120, v118
v_sub_f32 v121, v112, v120
v_sub_f32 v122, v114, v120
v_sub_f32 v123, v116, v120
v_sub_f32 v124, v118, v120
v_exp_f32 v121, v121
v_exp_f32 v122, v122
v_exp_f32 v123, v123
v_exp_f32 v124, v124
v_mul_f32 v127, v121, v113
v_fmac_f32 v127, v122, v115
v_fmac_f32 v127, v123, v117
v_fmac_f32 v127, v124, v119
s_waitcnt lgkmcnt(0)
v_mul_f32 v96, v121, v96
v_mul_f32 v97, v121, v97
v_mul_f32 v98, v121, v98
v_mul_f32 v99, v121, v99
v_fmac_f32 v96, v122, v100
v_fmac_f32 v97, v122, v101
v_fmac_f32 v98, v122, v102
v_fmac_f32 v99, v122, v103
v_fmac_f32 v96, v123, v104
v_fmac_f32 v97, v123, v105
v_fmac_f32 v98, v123, v106
v_fmac_f32 v99, v123, v107
v_fmac_f32 v96, v124, v108
v_fmac_f32 v97, v124, v109
v_fmac_f32 v98, v124, v110
v_fmac_f32 v99, v124, v111
s_mov_b32 s32, 0
s_mov_b32 s33, 1
v_cndmask_b32_e64 v96, v96, v120, s[32:33]
v_cndmask_b32_e64 v97, v97, v127, s[32:33]
v_cndmask_b32_e64 v98, v98, 0, s[32:33]
v_cndmask_b32_e64 v99, v99, 0, s[32:33]
v_lshlrev_b32 v125, 4, v1
s_mov_b32 exec_lo, 0xffffffff
s_mov_b32 exec_hi, 0x1
buffer_store_dwordx4 v[96:99], v125, s[4:7], s88 offen sc1
s_mov_b64 exec, -1
s_nop 0
Lnp_124:
Ldk_123:
s_add_u32 s82, s82, 1
s_cmp_lt_u32 s82, 4
s_cbranch_scc1 L_cloop_s
s_waitcnt vmcnt(0)
s_endpgm
L_exit:
s_endpgm
.section .rodata,"a"
.p2align 6
.amdhsa_kernel interleave_layers__mha_block_cached__dense_activation_gelu__decode_kernel
  .amdhsa_next_free_vgpr 512
  .amdhsa_next_free_sgpr 102
  .amdhsa_accum_offset 256
  .amdhsa_group_segment_fixed_size 0
  .amdhsa_kernarg_size 104
  .amdhsa_user_sgpr_count 2
  .amdhsa_user_sgpr_kernarg_segment_ptr 1
  .amdhsa_system_sgpr_workgroup_id_x 1
.end_amdhsa_kernel
```
